```python
import torch

def _softmax(x, axis=-1):
    return torch.softmax(x, dim=axis)
def _gelu(x):
    return torch.nn.functional.gelu(x, approximate="tanh")
def _silu(x):
    return torch.nn.functional.silu(x)
def _sigmoid(x):
    return torch.sigmoid(x)
def _layernorm(x, axis=-1, eps=1e-5):
    m = x.mean(dim=axis, keepdim=True)
    v = x.var(dim=axis, keepdim=True, unbiased=False)
    return (x - m) / torch.sqrt(v + eps)
def _scatter_add(tgt, idx, src, axis=0):
    return tgt.clone().index_add_(axis, idx, src)
def _segment_sum(src, seg, n):
    out = torch.zeros((n,) + src.shape[1:], dtype=src.dtype)
    return out.index_add_(0, seg, src)
def _pad(x, pw):
    flat = tuple(v for pair in reversed(pw) for v in pair)
    return torch.nn.functional.pad(x, flat)

kernel_name = 'interleave_layers__mha_block__mixer_channel_mlp__prompt'

def setup_inputs():

    _w = (lambda a: (lambda t: t.to(torch.bfloat16) if t.is_floating_point() else t)(torch.as_tensor(a)))
    def _A_setup():
        B, S, D, H = 1, 2048, 512, 32
        return {
            "x": _w((lambda *s: torch.randn(*s, dtype=torch.bfloat16) * 0.05)(B, S, D)),
            "wqkv": _w((lambda *s: torch.randn(*s, dtype=torch.bfloat16) * 0.05)(D, 3 * D)),
            "wo": _w((lambda *s: torch.randn(*s, dtype=torch.bfloat16) * 0.05)(D, D)),
        }
    _A_in = _A_setup()

    def _B_setup():
        B, S, D, F = 1, 2048, 512, 1792
        return {
            "x": _w((lambda *s: torch.randn(*s, dtype=torch.bfloat16) * 0.05)(B, S, D)),
            "w1": _w((lambda *s: torch.randn(*s, dtype=torch.bfloat16) * 3.2)(D, F) * (D ** -0.5)),
            "b1": _w((lambda *s: torch.randn(*s, dtype=torch.bfloat16) * 0.8)(F)),
            "w2": _w((lambda *s: torch.randn(*s, dtype=torch.bfloat16) * 0.2)(F, D) * (F ** -0.5)),
            "b2": _w((lambda *s: torch.randn(*s, dtype=torch.bfloat16) * 0.2)(D)),
        }
    _B_in = _B_setup()

    return {
        "A_x": _A_in["x"],
        "A_wqkv": _A_in["wqkv"],
        "A_wo": _A_in["wo"],
        "B_x": _B_in["x"],
        "B_w1": _B_in["w1"],
        "B_b1": _B_in["b1"],
        "B_w2": _B_in["w2"],
        "B_b2": _B_in["b2"],
    }

def reference(A_x, A_wqkv, A_wo, B_x, B_w1, B_b1, B_w2, B_b2):
    def _A_ref(x, wqkv, wo):
        B, S, D = x.shape
        H = 32
        Dh = D // H
        qkv = (lambda x, *d: x.permute(*d))((x @ wqkv).reshape(B, S, 3, H, Dh), 2, 0, 3, 1, 4)
        q, k, v = qkv[0], qkv[1], qkv[2]
        scores = torch.einsum("bhqd,bhkd->bhqk", q, k) * (Dh ** -0.5)
        p = _softmax(scores, axis=-1)
        o = torch.einsum("bhqk,bhkd->bhqd", p, v)
        return (lambda x, *d: x.permute(*d))(o, 0, 2, 1, 3).reshape(B, S, D) @ wo

    def _B_ref(x, w1, b1, w2, b2):
        y = _layernorm(x, axis=-1)
        h = _gelu(torch.einsum("bsd,df->bsf", y, w1) + b1)
        return torch.einsum("bsf,fd->bsd", h, w2) + b2

    x = A_x
    x = x + _A_ref(_layernorm(x, axis=-1), A_wqkv, A_wo)
    x = x + _B_ref(_layernorm(x, axis=-1), B_w1, B_b1, B_w2, B_b2)
    x = x + _A_ref(_layernorm(x, axis=-1), A_wqkv, A_wo)
    x = x + _B_ref(_layernorm(x, axis=-1), B_w1, B_b1, B_w2, B_b2)
    return x
```

```asm
; @launch kernel=mega_kernel grid=(256,1,1) block=(512,1,1) lds=163840
.amdgcn_target "amdgcn-amd-amdhsa--gfx950"
.text
.globl mega_kernel
.p2align 8
.type mega_kernel,@function
mega_kernel:
    s_load_dwordx16 s[80:95], s[0:1], 0
    s_getpc_b64 s[72:73]
mega_kernel_pcb:
    s_bfe_u32 s36, s2, 0x30003
    s_mov_b32 s74, (mega_kernel_cend-mega_kernel_pcb)/512*64
    s_mul_i32 s36, s36, s74
    s_add_u32 s72, s72, s36
    s_addc_u32 s73, s73, 0
    s_mov_b32 s75, 0x00020000
    v_lshlrev_b32 v8, 6, v0
    buffer_load_dword v255, v8, s[72:75], 0 offen
    s_cmpk_ge_u32 s2, 256
    s_cbranch_scc1 mega_kernel_end
    s_load_dwordx2 s[8:9], s[0:1], 80
    s_load_dwordx2 s[28:29], s[0:1], 64
    s_getreg_b32 s98, hwreg(HW_REG_XCC_ID)
    s_lshr_b32 s13, s2, 3
    v_lshrrev_b32 v1, 6, v0
    v_and_b32 v0, 63, v0
    v_readfirstlane_b32 s3, v1
    s_and_b32 s98, s98, 7
    s_mov_b32 s12, s98
    s_mov_b32 s10, 0xf00000
    s_mov_b32 s11, 0x00020000
    s_mov_b32 s6, 0x600000
    s_mov_b32 s7, 0x00020000
    s_mov_b32 s58, 0x940000
    s_mov_b32 s59, 0x00020000
    s_mov_b32 s30, 2097152
    s_mov_b32 s31, 0x00020000
    s_mov_b32 s26, 1024
    s_mov_b32 s27, 0x00020000
    s_mov_b32 s66, 2097152
    s_mov_b32 s67, 0x00020000
    s_mov_b32 s70, 1572864
    s_mov_b32 s71, 0x00020000
    s_mov_b32 s75, 0x00020000
    s_mov_b32 s79, 0x00020000
    s_mov_b32 s78, 0
    s_mov_b32 s14, 0
    s_mov_b32 s15, 0
    s_mov_b32 s96, 63
    s_mov_b32 s97, 0
    s_and_b32 s16, s3, 3
    s_lshr_b32 s17, s3, 2
    v_mov_b32 v7, 0
    v_lshlrev_b32 v1, 4, v0
    v_lshrrev_b32 v10, 5, v0
    v_and_b32 v11, 31, v0
    v_and_b32 v2, 15, v0
    v_lshlrev_b32 v2, 4, v2
    v_lshl_add_u32 v2, v10, 8, v2
    v_bfe_u32 v3, v0, 4, 1
    v_lshl_add_u32 v2, v3, 9, v2
    v_add_u32 v3, 0x10000, v2
    v_lshlrev_b32 v5, 4, v11
    v_lshl_add_u32 v4, v10, 11, v5
    v_lshl_add_u32 v5, v10, 2, v5
    v_mov_b32 v6, 0x3f803f80
mega_kernel_role:
    s_lshl_b32 s36, s12, 3
    s_and_b32 s37, s13, 1
    s_lshl_b32 s37, s37, 2
    s_add_u32 s18, s36, s37
    s_add_u32 s18, s18, s16
    s_lshr_b32 s19, s13, 1
    s_and_b32 s37, s13, 3
    s_lshl_b32 s37, s37, 1
    s_add_u32 s20, s36, s37
    s_lshr_b32 s21, s13, 2
    s_lshr_b32 s36, s16, 1
    s_add_u32 s36, s36, s20
    s_and_b32 s37, s16, 1
    s_lshl_b32 s38, s21, 1
    s_add_u32 s38, s38, s37
    s_lshl_b32 s22, s36, 15
    s_lshl_b32 s39, s38, 11
    s_add_u32 s22, s22, s39
    s_lshl_b32 s23, s36, 12
    s_lshl_b32 s39, s21, 9
    s_add_u32 s23, s23, s39
    s_lshl_b32 s39, s37, 3
    s_add_u32 s23, s23, s39
    s_lshl_b32 s32, s36, 7
    s_lshl_b32 s39, s38, 2
    s_add_u32 s32, s32, s39
    s_lshl_b32 s33, s13, 1
    s_add_u32 s33, s33, s19
    s_and_b32 s33, s33, 3
    v_lshrrev_b32 v12, 2, v0
    v_mul_u32_u24 v12, 3072, v12
    v_and_b32 v13, 3, v0
    v_lshl_add_u32 v12, v13, 4, v12
    v_bfe_u32 v22, v0, 2, 2
    v_lshlrev_b32 v22, 6, v22
    v_lshl_add_u32 v22, v13, 3, v22
    v_bfe_u32 v13, v0, 4, 1
    v_lshl_add_u32 v22, v13, 5, v22
    v_lshrrev_b32 v10, 5, v0
    s_mul_i32 s40, s17, 1572860
    s_mul_i32 s41, s17, 2097148
    s_mul_i32 s42, s17, 1835004
    s_mul_i32 s43, s17, 524284
    s_lshl_b32 s44, s3, 21
    s_add_u32 s44, s44, 0x400
    s_add_u32 s45, s44, 0x1000000
    s_cmp_eq_u32 s96, 0
    s_waitcnt lgkmcnt(0)
    s_cbranch_scc1 mega_kernel_go
    s_mov_b32 s64, s80
    s_mov_b32 s65, s81
    s_mov_b32 s68, s82
    s_mov_b32 s69, s83
    s_add_u32 s4, s8, 0xf00000
    s_addc_u32 s5, s9, 0
    s_add_u32 s56, s8, 0x1500000
    s_addc_u32 s57, s9, 0
    s_mov_b32 s24, s94
    s_mov_b32 s25, s95
    s_mov_b32 s76, s90
    s_mov_b32 s77, s91
mega_kernel_go:
    s_cmp_eq_u32 s17, 0
    s_cbranch_scc1 mega_kernel_qkv0_c
    s_cmp_eq_u32 s3, 7
    s_cselect_b32 s46, s96, 0
    s_cmp_lg_u32 s46, 0
    s_cselect_b32 s36, 0, 0x80000000
    v_mov_b32 v13, 0x80000000
    v_mov_b32 v14, 0x80000000
    v_writelane_b32 v13, s36, 0
    s_or_b32 s60, s36, s2
    s_lshl_b32 s54, s19, 6
    s_mul_i32 s41, s16, 98304
    s_add_u32 s54, s54, s41
    s_add_u32 s54, s54, 1024
    s_lshl_b32 s34, s16, 12
    s_add_u32 s41, s33, 0
    s_and_b32 s41, s41, 3
    s_mul_i32 s41, s41, 393216
    s_add_u32 m0, s34, 0
    s_add_u32 s41, s41, s54
    buffer_load_dwordx4 v12, s[68:71], s41 offen lds
    buffer_load_dwordx4 v12, s[68:71], s41 offen offset:1024 lds
    s_add_u32 m0, m0, 2048
    s_add_u32 s41, s41, 49152
    buffer_load_dwordx4 v12, s[68:71], s41 offen lds
    buffer_load_dwordx4 v12, s[68:71], s41 offen offset:1024 lds
    s_and_b32 s60, s2, 7
    s_lshl_b32 s60, s60, 5
    s_lshr_b32 s37, s2, 3
    s_or_b32 s60, s60, s37
    s_sub_u32 s37, s60, 1
    s_cmp_lt_u32 s37, 7
    s_cselect_b32 s37, s96, 0
    s_cmp_eq_u32 s3, 6
    s_cselect_b32 s37, s37, 0
    s_cmp_lg_u32 s46, 0
    s_cselect_b64 exec, 0xff, 0
    s_and_b32 s36, s2, 7
    s_lshl_b32 s36, s36, 7
    v_max_u32 v13, 1, v0
    v_lshl_add_u32 v13, v13, 2, s36
    s_mov_b64 exec, -1
    s_cmp_lg_u32 s37, 0
    s_cbranch_scc1 mega_kernel_lead
mega_kernel_led:
    buffer_load_dword v16, v13, s[8:11], 0 offen sc1
    s_add_u32 s36, s8, 0x400
    s_addc_u32 s37, s9, 0
    s_mov_b32 s38, 0x2000000
    s_mov_b32 s39, 0x00020000
    s_mov_b32 s44, 2097156
    s_mov_b64 s[40:41], s[28:29]
    s_mov_b32 s42, 2097152
    s_mov_b32 s43, 0x00020000
    s_cmp_eq_u32 s16, 1
    s_cselect_b64 s[36:37], s[88:89], s[36:37]
    s_cselect_b64 s[40:41], s[90:91], s[40:41]
    s_cselect_b32 s38, 1835008, s38
    s_cselect_b32 s42, 8, s42
    s_cmp_eq_u32 s16, 2
    s_cselect_b64 s[36:37], s[92:93], s[36:37]
    s_cselect_b64 s[40:41], s[94:95], s[40:41]
    s_cselect_b32 s38, 1835008, s38
    s_cselect_b32 s42, 8, s42
    s_cmp_eq_u32 s16, 3
    s_cselect_b64 s[36:37], s[84:85], s[36:37]
    s_cselect_b32 s38, 524288, s38
    s_cselect_b32 s42, 0, s42
    s_min_u32 s44, s44, s38
    s_sub_u32 s44, s44, 4
    v_mul_u32_u24 v8, s44, v0
    v_mul_u32_u24 v9, 2097148, v0
    buffer_load_dword v15, v8, s[36:39], 0 offen sc1
    buffer_load_dword v15, v9, s[40:43], 0 offen sc1
    s_lshl_b32 s36, s13, 2
    s_add_u32 s36, s36, s16
    s_mul_i32 s36, s36, 12288
    s_lshr_b32 s37, s68, 7
    s_sub_u32 s37, 3, s37
    s_and_b32 s37, s37, 7
    s_add_u32 s37, s37, 8
    v_and_b32 v8, 3, v0
    v_mul_u32_u24 v8, 3072, v8
    v_bfe_u32 v9, v0, 2, 3
    v_and_b32 v11, 4, v0
    v_lshl_add_u32 v11, v11, 1, s37
    v_cmp_gt_u32 vcc, 32, v0
    s_nop 1
    v_cndmask_b32 v9, v11, v9, vcc
    v_lshl_add_u32 v8, v9, 7, v8
    s_mov_b32 exec_hi, 0xff
    buffer_load_dword v15, v8, s[68:71], s36 offen
    s_mov_b64 exec, -1
    s_add_u32 s41, s33, 1
    s_and_b32 s41, s41, 3
    s_mul_i32 s41, s41, 393216
    s_add_u32 m0, s34, 16384
    s_add_u32 s41, s41, s54
    buffer_load_dwordx4 v12, s[68:71], s41 offen lds
    buffer_load_dwordx4 v12, s[68:71], s41 offen offset:1024 lds
    s_add_u32 m0, m0, 2048
    s_add_u32 s41, s41, 49152
    buffer_load_dwordx4 v12, s[68:71], s41 offen lds
    buffer_load_dwordx4 v12, s[68:71], s41 offen offset:1024 lds
    s_mov_b32 s78, 0
    s_cmp_ge_u32 s2, 112
    s_cbranch_scc1 mega_kernel_cv_n1
    s_mov_b32 s72, s88
    s_mov_b32 s73, s89
    s_mov_b32 s74, 1835008
    s_movk_i32 s47, 3584
    s_movk_i32 s50, 3072
    s_and_b32 s36, s2, 3
    s_andn2_b32 s37, s2, 3
    s_add_u32 s37, s37, s16
    s_lshl_b32 s52, s37, 5
    s_mul_i32 s48, s36, 458752
    s_andn2_b32 s39, s52, 127
    s_add_u32 s48, s48, s39
    s_mul_i32 s38, s37, 147
    s_lshr_b32 s38, s38, 10
    s_mul_i32 s39, s38, 7
    s_sub_u32 s39, s37, s39
    s_mul_i32 s38, s38, 118272
    s_cmp_ge_u32 s39, 6
    s_cmovk_i32 s50, 512
    s_cselect_b32 s37, 98304, 0
    s_lshl_b32 s39, s39, 9
    s_add_u32 s38, s38, s39
    s_add_u32 s38, s38, s37
    s_add_u32 s38, s38, 0x190000
    s_lshl_b32 s49, s50, 3
    s_mul_i32 s49, s49, s36
    s_add_u32 s49, s49, s38
    s_lshr_b32 s51, s36, 1
    s_lshl_b32 s51, s51, 8
    s_add_u32 s51, s51, s38
    s_and_b32 s37, s36, 1
    s_lshl_b32 s37, s37, 7
    s_add_u32 s51, s51, s37
    s_lshl_b32 s37, s50, 5
    s_add_u32 s51, s51, s37
    s_cmp_lt_u32 s36, 2
    s_cselect_b32 s78, 3584, 0
    s_branch mega_kernel_cv_go
mega_kernel_cv_n1:
    s_mov_b32 s72, s92
    s_mov_b32 s73, s93
    s_mov_b32 s74, 1835008
    s_sub_u32 s36, s2, 112
    s_mov_b32 s38, 231424
    s_mov_b32 s39, 0x3e0000
    s_mov_b32 s52, 0
    s_mov_b32 s51, 0
    s_cmp_lt_u32 s2, 224
    s_cbranch_scc1 mega_kernel_cv_n2
    s_mov_b32 s72, s84
    s_mov_b32 s73, s85
    s_mov_b32 s74, 524288
    s_sub_u32 s36, s2, 224
    s_mov_b32 s38, 65536
    s_mov_b32 s39, 0x360000
mega_kernel_cv_n2:
    s_movk_i32 s47, 1024
    s_movk_i32 s50, 2048
    s_and_b32 s37, s36, 7
    s_lshr_b32 s36, s36, 3
    s_lshl_b32 s48, s36, 17
    s_lshl_b32 s49, s37, 7
    s_add_u32 s48, s48, s49
    s_mul_i32 s49, s37, s38
    s_add_u32 s49, s49, s39
    s_lshl_b32 s36, s36, 14
    s_add_u32 s49, s49, s36
    s_lshl_b32 s36, s16, 9
    s_add_u32 s49, s49, s36
mega_kernel_cv_go:
    s_lshl_b32 s36, s47, 5
    s_mul_i32 s36, s36, s16
    s_add_u32 s48, s48, s36
    v_lshrrev_b32 v104, 1, v0
    v_mul_u32_u24 v104, s47, v104
    v_and_b32 v11, 1, v0
    v_lshl_add_u32 v104, v11, 6, v104
    s_lshr_b32 s36, s2, 6
    s_cmp_lt_u32 s2, 32
    s_cselect_b32 s36, 3, s36
    s_cmp_lg_u32 s3, 6
    s_cselect_b32 s36, 3, s36
    s_cmp_eq_u32 s96, 0
    s_cselect_b32 s36, 3, s36
    s_cmp_eq_u32 s36, 3
    s_cbranch_scc1 mega_kernel_noclr
    s_mul_i32 s36, s36, 0x500000
    s_and_b32 s37, s2, 63
    s_lshl_b32 s37, s37, 10
    s_add_u32 s36, s36, s37
    v_mov_b32 v32, 0
    v_mov_b32 v33, 0
    v_mov_b32 v34, 0
    v_mov_b32 v35, 0
    buffer_store_dwordx4 v[32:35], v1, s[8:11], s36 offen sc1
mega_kernel_noclr:
    v_lshrrev_b32 v8, 3, v0
    v_mul_u32_u24 v23, s47, v8
    v_and_b32 v8, 0x70, v1
    v_add_u32 v23, v23, v8
    v_and_b32 v25, 15, v0
    v_lshlrev_b32 v25, 1, v25
    v_mul_u32_u24 v24, s50, v10
    v_and_b32 v8, 0x1f0, v1
    v_add_u32 v24, v24, v8
    s_lshl_b32 s53, s47, 3
    s_sub_u32 s53, s53, 1024
    v_bfe_u32 v8, v0, 2, 3
    v_lshl_add_u32 v8, v10, 4, v8
    v_and_b32 v9, 3, v0
    v_lshlrev_b32 v9, 3, v9
    v_lshl_add_u32 v29, v8, 7, v9
    s_lshl_b32 s36, s16, 5
    v_add_u32 v29, s36, v29
    v_lshl_add_u32 v17, v10, 8, v22
    s_lshl_b32 s36, s16, 11
    s_add_u32 s37, s36, 98304
    v_add_u32 v18, s37, v17
    s_lshl_b32 s36, s16, 12
    v_add_u32 v17, s36, v17
    v_and_b32 v21, 0x2ff, v2
    s_lshr_b32 s36, s16, 1
    s_lshl_b32 s36, s36, 8
    s_and_b32 s37, s16, 1
    s_lshl_b32 s37, s37, 3
    s_add_u32 s36, s36, s37
    v_add_u32 v21, s36, v21
    v_add_u32 v20, 131072, v21
    s_lshr_b32 s36, s18, 2
    s_and_b32 s37, s36, 3
    s_lshr_b32 s45, s36, 2
    s_sub_u32 s45, s45, s33
    s_and_b32 s45, s45, 3
    s_cmp_eq_u32 s37, s16
    s_cselect_b32 s55, s45, 99
    s_mul_i32 s99, s19, 101376
    s_add_u32 s99, s99, 0x0
    s_mul_i32 s100, s36, 6144
    s_add_u32 s100, s100, s99
    s_add_u32 s101, s100, 3072
    s_add_u32 s99, s99, 98304
    v_mov_b32 v19, 1
    v_add_u32 v206, s49, v24
    s_lshl_b32 s36, s50, 1
    v_add_u32 v207, s36, v206
    v_add_u32 v208, s36, v207
    v_add_u32 v209, s36, v208
    v_lshl_add_u32 v210, v25, 2, s51
    v_mov_b32 v211, v29
    v_add_u32 v200, s48, v23
    v_add_u32 v201, s53, v200
    v_add_u32 v202, s53, v201
    v_add_u32 v203, s53, v202
    v_add_u32 v204, s52, v25
    s_mov_b32 s35, 0xffff0000
    s_waitcnt vmcnt(8)
    s_barrier
    s_add_u32 s41, s33, 2
    s_and_b32 s41, s41, 3
    s_mul_i32 s41, s41, 393216
    s_add_u32 m0, s34, 32768
    s_add_u32 s41, s41, s54
    buffer_load_dwordx4 v12, s[68:71], s41 offen lds
    buffer_load_dwordx4 v12, s[68:71], s41 offen offset:1024 lds
    s_add_u32 m0, m0, 2048
    s_add_u32 s41, s41, 49152
    buffer_load_dwordx4 v12, s[68:71], s41 offen lds
    buffer_load_dwordx4 v12, s[68:71], s41 offen offset:1024 lds
    s_waitcnt lgkmcnt(0)
    ds_read_b64_tr_b16 v[32:33], v17 offset:0
    ds_read_b64_tr_b16 v[34:35], v17 offset:512
    ds_read_b64_tr_b16 v[36:37], v17 offset:1024
    ds_read_b64_tr_b16 v[38:39], v17 offset:1536
    ds_read_b64_tr_b16 v[40:41], v17 offset:2048
    ds_read_b64_tr_b16 v[42:43], v17 offset:2560
    ds_read_b64_tr_b16 v[44:45], v17 offset:3072
    ds_read_b64_tr_b16 v[46:47], v17 offset:3584
    s_waitcnt vmcnt(11)
    buffer_atomic_add v19, v14, s[8:11], 0 offen sc1
    s_waitcnt lgkmcnt(6)
    v_dot2_f32_bf16 v8, v32, v6, 0
    v_dot2_f32_bf16 v8, v33, v6, v8
    v_dot2_f32_bf16 v8, v34, v6, v8
    v_dot2_f32_bf16 v8, v35, v6, v8
    s_waitcnt lgkmcnt(4)
    v_dot2_f32_bf16 v9, v36, v6, 0
    v_dot2_f32_bf16 v9, v37, v6, v9
    v_dot2_f32_bf16 v9, v38, v6, v9
    v_dot2_f32_bf16 v9, v39, v6, v9
    s_waitcnt lgkmcnt(2)
    v_dot2_f32_bf16 v8, v40, v6, v8
    v_dot2_f32_bf16 v8, v41, v6, v8
    v_dot2_f32_bf16 v8, v42, v6, v8
    v_dot2_f32_bf16 v8, v43, v6, v8
    s_waitcnt lgkmcnt(0)
    v_dot2_f32_bf16 v9, v44, v6, v9
    v_dot2_f32_bf16 v9, v45, v6, v9
    v_dot2_f32_bf16 v9, v46, v6, v9
    v_dot2_f32_bf16 v9, v47, v6, v9
    s_cmp_lg_u32 s55, 0
    s_cbranch_scc1 mega_kernel_ncp1
    buffer_store_dwordx4 v[32:35], v2, s[4:7], s100 offen offset:1024 sc1
    buffer_store_dwordx4 v[36:39], v2, s[4:7], s100 offen offset:2048 sc1
    buffer_store_dwordx4 v[40:43], v2, s[4:7], s101 offen offset:1024 sc1
    buffer_store_dwordx4 v[44:47], v2, s[4:7], s101 offen offset:2048 sc1
mega_kernel_ncp1:
    s_waitcnt vmcnt(5)
    s_barrier
    s_add_u32 s41, s33, 3
    s_and_b32 s41, s41, 3
    s_mul_i32 s41, s41, 393216
    s_add_u32 m0, s34, 49152
    s_add_u32 s41, s41, s54
    buffer_load_dwordx4 v12, s[68:71], s41 offen lds
    buffer_load_dwordx4 v12, s[68:71], s41 offen offset:1024 lds
    s_add_u32 m0, m0, 2048
    s_add_u32 s41, s41, 49152
    buffer_load_dwordx4 v12, s[68:71], s41 offen lds
    buffer_load_dwordx4 v12, s[68:71], s41 offen offset:1024 lds
    ds_read_b64_tr_b16 v[32:33], v17 offset:16384
    ds_read_b64_tr_b16 v[34:35], v17 offset:16896
    ds_read_b64_tr_b16 v[36:37], v17 offset:17408
    ds_read_b64_tr_b16 v[38:39], v17 offset:17920
    ds_read_b64_tr_b16 v[40:41], v17 offset:18432
    ds_read_b64_tr_b16 v[42:43], v17 offset:18944
    ds_read_b64_tr_b16 v[44:45], v17 offset:19456
    ds_read_b64_tr_b16 v[46:47], v17 offset:19968
    s_waitcnt lgkmcnt(6)
    v_dot2_f32_bf16 v8, v32, v6, v8
    v_dot2_f32_bf16 v8, v33, v6, v8
    v_dot2_f32_bf16 v8, v34, v6, v8
    v_dot2_f32_bf16 v8, v35, v6, v8
    s_waitcnt lgkmcnt(4)
    v_dot2_f32_bf16 v9, v36, v6, v9
    v_dot2_f32_bf16 v9, v37, v6, v9
    v_dot2_f32_bf16 v9, v38, v6, v9
    v_dot2_f32_bf16 v9, v39, v6, v9
    s_waitcnt lgkmcnt(2)
    v_dot2_f32_bf16 v8, v40, v6, v8
    v_dot2_f32_bf16 v8, v41, v6, v8
    v_dot2_f32_bf16 v8, v42, v6, v8
    v_dot2_f32_bf16 v8, v43, v6, v8
    s_waitcnt lgkmcnt(0)
    v_dot2_f32_bf16 v9, v44, v6, v9
    v_dot2_f32_bf16 v9, v45, v6, v9
    v_dot2_f32_bf16 v9, v46, v6, v9
    v_dot2_f32_bf16 v9, v47, v6, v9
    s_cmp_lg_u32 s55, 1
    s_cbranch_scc1 mega_kernel_ncp2
    buffer_store_dwordx4 v[32:35], v2, s[4:7], s100 offen offset:1024 sc1
    buffer_store_dwordx4 v[36:39], v2, s[4:7], s100 offen offset:2048 sc1
    buffer_store_dwordx4 v[40:43], v2, s[4:7], s101 offen offset:1024 sc1
    buffer_store_dwordx4 v[44:47], v2, s[4:7], s101 offen offset:2048 sc1
mega_kernel_ncp2:
    s_waitcnt vmcnt(5)
    s_barrier
    s_lshr_b32 s41, s34, 1
    s_add_u32 m0, s41, 98304
    s_add_u32 s41, s33, 0
    s_and_b32 s41, s41, 3
    s_mul_i32 s41, s41, 393216
    s_add_u32 s41, s41, s54
    s_sub_u32 s41, s41, 1024
    buffer_load_dwordx4 v12, s[68:71], s41 offen lds
    s_add_u32 s41, s41, 48128
    buffer_load_dwordx4 v12, s[68:71], s41 offen offset:1024 lds
    s_add_u32 m0, m0, 8192
    s_add_u32 s41, s33, 1
    s_and_b32 s41, s41, 3
    s_mul_i32 s41, s41, 393216
    s_add_u32 s41, s41, s54
    s_sub_u32 s41, s41, 1024
    buffer_load_dwordx4 v12, s[68:71], s41 offen lds
    s_add_u32 s41, s41, 48128
    buffer_load_dwordx4 v12, s[68:71], s41 offen offset:1024 lds
    s_add_u32 m0, m0, 8192
    s_add_u32 s41, s33, 2
    s_and_b32 s41, s41, 3
    s_mul_i32 s41, s41, 393216
    s_add_u32 s41, s41, s54
    s_sub_u32 s41, s41, 1024
    buffer_load_dwordx4 v12, s[68:71], s41 offen lds
    s_add_u32 s41, s41, 48128
    buffer_load_dwordx4 v12, s[68:71], s41 offen offset:1024 lds
    s_add_u32 m0, m0, 8192
    s_add_u32 s41, s33, 3
    s_and_b32 s41, s41, 3
    s_mul_i32 s41, s41, 393216
    s_add_u32 s41, s41, s54
    s_sub_u32 s41, s41, 1024
    buffer_load_dwordx4 v12, s[68:71], s41 offen lds
    s_add_u32 s41, s41, 48128
    buffer_load_dwordx4 v12, s[68:71], s41 offen offset:1024 lds
    ds_read_b64_tr_b16 v[32:33], v17 offset:32768
    ds_read_b64_tr_b16 v[34:35], v17 offset:33280
    ds_read_b64_tr_b16 v[36:37], v17 offset:33792
    ds_read_b64_tr_b16 v[38:39], v17 offset:34304
    ds_read_b64_tr_b16 v[40:41], v17 offset:34816
    ds_read_b64_tr_b16 v[42:43], v17 offset:35328
    ds_read_b64_tr_b16 v[44:45], v17 offset:35840
    ds_read_b64_tr_b16 v[46:47], v17 offset:36352
    buffer_load_dword v27, v13, s[8:11], 0 offen sc1
    s_waitcnt lgkmcnt(6)
    v_dot2_f32_bf16 v8, v32, v6, v8
    v_dot2_f32_bf16 v8, v33, v6, v8
    v_dot2_f32_bf16 v8, v34, v6, v8
    v_dot2_f32_bf16 v8, v35, v6, v8
    s_waitcnt lgkmcnt(4)
    v_dot2_f32_bf16 v9, v36, v6, v9
    v_dot2_f32_bf16 v9, v37, v6, v9
    v_dot2_f32_bf16 v9, v38, v6, v9
    v_dot2_f32_bf16 v9, v39, v6, v9
    s_waitcnt lgkmcnt(2)
    v_dot2_f32_bf16 v8, v40, v6, v8
    v_dot2_f32_bf16 v8, v41, v6, v8
    v_dot2_f32_bf16 v8, v42, v6, v8
    v_dot2_f32_bf16 v8, v43, v6, v8
    s_waitcnt lgkmcnt(0)
    v_dot2_f32_bf16 v9, v44, v6, v9
    v_dot2_f32_bf16 v9, v45, v6, v9
    v_dot2_f32_bf16 v9, v46, v6, v9
    v_dot2_f32_bf16 v9, v47, v6, v9
    s_cmp_lg_u32 s55, 2
    s_cbranch_scc1 mega_kernel_ncp3
    buffer_store_dwordx4 v[32:35], v2, s[4:7], s100 offen offset:1024 sc1
    buffer_store_dwordx4 v[36:39], v2, s[4:7], s100 offen offset:2048 sc1
    buffer_store_dwordx4 v[40:43], v2, s[4:7], s101 offen offset:1024 sc1
    buffer_store_dwordx4 v[44:47], v2, s[4:7], s101 offen offset:2048 sc1
mega_kernel_ncp3:
    s_waitcnt vmcnt(9)
    s_barrier
    ds_read_b64_tr_b16 v[32:33], v17 offset:49152
    ds_read_b64_tr_b16 v[34:35], v17 offset:49664
    ds_read_b64_tr_b16 v[36:37], v17 offset:50176
    ds_read_b64_tr_b16 v[38:39], v17 offset:50688
    ds_read_b64_tr_b16 v[40:41], v17 offset:51200
    ds_read_b64_tr_b16 v[42:43], v17 offset:51712
    ds_read_b64_tr_b16 v[44:45], v17 offset:52224
    ds_read_b64_tr_b16 v[46:47], v17 offset:52736
    buffer_load_dword v28, v13, s[8:11], 0 offen sc1
    s_waitcnt lgkmcnt(6)
    v_dot2_f32_bf16 v8, v32, v6, v8
    v_dot2_f32_bf16 v8, v33, v6, v8
    v_dot2_f32_bf16 v8, v34, v6, v8
    v_dot2_f32_bf16 v8, v35, v6, v8
    s_waitcnt lgkmcnt(4)
    v_dot2_f32_bf16 v9, v36, v6, v9
    v_dot2_f32_bf16 v9, v37, v6, v9
    v_dot2_f32_bf16 v9, v38, v6, v9
    v_dot2_f32_bf16 v9, v39, v6, v9
    s_waitcnt lgkmcnt(2)
    v_dot2_f32_bf16 v8, v40, v6, v8
    v_dot2_f32_bf16 v8, v41, v6, v8
    v_dot2_f32_bf16 v8, v42, v6, v8
    v_dot2_f32_bf16 v8, v43, v6, v8
    s_waitcnt lgkmcnt(0)
    v_dot2_f32_bf16 v9, v44, v6, v9
    v_dot2_f32_bf16 v9, v45, v6, v9
    v_dot2_f32_bf16 v9, v46, v6, v9
    v_dot2_f32_bf16 v9, v47, v6, v9
    s_cmp_lg_u32 s55, 3
    s_cbranch_scc1 mega_kernel_ncp4
    buffer_store_dwordx4 v[32:35], v2, s[4:7], s100 offen offset:1024 sc1
    buffer_store_dwordx4 v[36:39], v2, s[4:7], s100 offen offset:2048 sc1
    buffer_store_dwordx4 v[40:43], v2, s[4:7], s101 offen offset:1024 sc1
    buffer_store_dwordx4 v[44:47], v2, s[4:7], s101 offen offset:2048 sc1
mega_kernel_ncp4:
    v_mov_b32 v48, v8
    v_mov_b32 v49, v9
    s_nop 0
    v_permlane32_swap_b32 v48, v8
    v_permlane32_swap_b32 v49, v9
    v_add_f32 v8, v8, v48
    v_add_f32 v9, v9, v49
    v_cvt_pk_bf16_f32 v52, v8, v8
    v_and_b32 v53, 0xffff0000, v52
    v_sub_f32 v53, v8, v53
    v_cvt_pk_bf16_f32 v53, v53, 0
    ds_write_b64 v20, v[52:53] offset:1024
    v_cvt_pk_bf16_f32 v54, v9, v9
    v_and_b32 v55, 0xffff0000, v54
    v_sub_f32 v55, v9, v55
    v_cvt_pk_bf16_f32 v55, v55, 0
    ds_write_b64 v20, v[54:55] offset:2048
    s_waitcnt vmcnt(2)
    s_waitcnt lgkmcnt(0)
    s_barrier
    ds_read_b64_tr_b16 v[64:65], v18 offset:0
    ds_read_b64_tr_b16 v[66:67], v18 offset:512
    ds_read_b64_tr_b16 v[68:69], v18 offset:1024
    ds_read_b64_tr_b16 v[70:71], v18 offset:1536
    ds_read_b64_tr_b16 v[72:73], v18 offset:8192
    ds_read_b64_tr_b16 v[74:75], v18 offset:8704
    ds_read_b64_tr_b16 v[76:77], v18 offset:9216
    ds_read_b64_tr_b16 v[78:79], v18 offset:9728
    ds_read_b64_tr_b16 v[80:81], v18 offset:16384
    ds_read_b64_tr_b16 v[82:83], v18 offset:16896
    ds_read_b64_tr_b16 v[84:85], v18 offset:17408
    ds_read_b64_tr_b16 v[86:87], v18 offset:17920
    ds_read_b64_tr_b16 v[88:89], v18 offset:24576
    ds_read_b64_tr_b16 v[90:91], v18 offset:25088
    ds_read_b64_tr_b16 v[92:93], v18 offset:25600
    ds_read_b64_tr_b16 v[94:95], v18 offset:26112
    v_and_b32 v32, 11, v0
    v_cmp_eq_u32 vcc, 0, v32
    s_nop 1
    v_cndmask_b32 v32, 0, v6, vcc
    v_mov_b32 v33, v32
    v_mov_b32 v34, v32
    v_mov_b32 v35, v32
    s_lshl_b32 s36, s16, 10
    s_add_u32 s36, s36, 159744
    v_add_u32 v12, s36, v1
    ds_write_b128 v12, v[32:35]
    s_lshl_b32 s36, s16, 12
    s_add_u32 s36, s36, 65536
    v_add_u32 v12, s36, v1
    s_waitcnt lgkmcnt(13)
    v_dot2_f32_bf16 v10, v64, v6, 0
    v_dot2_f32_bf16 v10, v65, v6, v10
    v_dot2_f32_bf16 v10, v66, v6, v10
    v_dot2_f32_bf16 v10, v67, v6, v10
    v_dot2_f32_bf16 v10, v68, v6, v10
    v_dot2_f32_bf16 v10, v69, v6, v10
    v_dot2_f32_bf16 v10, v70, v6, v10
    v_dot2_f32_bf16 v10, v71, v6, v10
    s_waitcnt lgkmcnt(9)
    v_dot2_f32_bf16 v10, v72, v6, v10
    v_dot2_f32_bf16 v10, v73, v6, v10
    v_dot2_f32_bf16 v10, v74, v6, v10
    v_dot2_f32_bf16 v10, v75, v6, v10
    v_dot2_f32_bf16 v10, v76, v6, v10
    v_dot2_f32_bf16 v10, v77, v6, v10
    v_dot2_f32_bf16 v10, v78, v6, v10
    v_dot2_f32_bf16 v10, v79, v6, v10
    s_waitcnt lgkmcnt(5)
    v_dot2_f32_bf16 v10, v80, v6, v10
    v_dot2_f32_bf16 v10, v81, v6, v10
    v_dot2_f32_bf16 v10, v82, v6, v10
    v_dot2_f32_bf16 v10, v83, v6, v10
    v_dot2_f32_bf16 v10, v84, v6, v10
    v_dot2_f32_bf16 v10, v85, v6, v10
    v_dot2_f32_bf16 v10, v86, v6, v10
    v_dot2_f32_bf16 v10, v87, v6, v10
    s_waitcnt lgkmcnt(1)
    v_dot2_f32_bf16 v10, v88, v6, v10
    v_dot2_f32_bf16 v10, v89, v6, v10
    v_dot2_f32_bf16 v10, v90, v6, v10
    v_dot2_f32_bf16 v10, v91, v6, v10
    v_dot2_f32_bf16 v10, v92, v6, v10
    v_dot2_f32_bf16 v10, v93, v6, v10
    v_dot2_f32_bf16 v10, v94, v6, v10
    v_dot2_f32_bf16 v10, v95, v6, v10
    s_nop 2
    v_mov_b32 v50, v10
    s_nop 1
    v_permlane32_swap_b32 v50, v10
    v_add_f32 v10, v10, v50
    v_cvt_pk_bf16_f32 v56, v10, v10
    v_and_b32 v57, 0xffff0000, v56
    v_sub_f32 v57, v10, v57
    v_cvt_pk_bf16_f32 v57, v57, 0
    ds_write_b64 v20, v[56:57] offset:0
    s_cmp_lg_u32 s55, 0
    s_cbranch_scc1 mega_kernel_ncq5
    buffer_store_dwordx4 v[64:67], v2, s[4:7], s100 offen sc1
    buffer_store_dwordx4 v[68:71], v2, s[4:7], s101 offen sc1
mega_kernel_ncq5:
    s_cmp_lg_u32 s55, 1
    s_cbranch_scc1 mega_kernel_ncq6
    buffer_store_dwordx4 v[72:75], v2, s[4:7], s100 offen sc1
    buffer_store_dwordx4 v[76:79], v2, s[4:7], s101 offen sc1
mega_kernel_ncq6:
    s_cmp_lg_u32 s55, 2
    s_cbranch_scc1 mega_kernel_ncq7
    buffer_store_dwordx4 v[80:83], v2, s[4:7], s100 offen sc1
    buffer_store_dwordx4 v[84:87], v2, s[4:7], s101 offen sc1
mega_kernel_ncq7:
    s_cmp_lg_u32 s55, 3
    s_cbranch_scc1 mega_kernel_ncq8
    buffer_store_dwordx4 v[88:91], v2, s[4:7], s100 offen sc1
    buffer_store_dwordx4 v[92:95], v2, s[4:7], s101 offen sc1
mega_kernel_ncq8:
    s_cmp_lg_u32 s46, 0
    s_cbranch_scc1 mega_kernel_achk
mega_kernel_achkd:
    s_waitcnt lgkmcnt(0)
    s_barrier
    ds_read_b128 v[32:35], v12 offset:0
    ds_read_b128 v[36:39], v12 offset:1024
    ds_read_b128 v[40:43], v12 offset:2048
    ds_read_b128 v[44:47], v12 offset:3072
    s_lshl_b32 s36, s16, 10
    v_add_u32 v20, s36, v1
    v_add_u32 v21, 131072, v20
    ds_read_b128 v[52:55], v21
    s_lshl_b32 s40, s19, 18
    s_lshr_b32 s41, s18, 2
    s_lshl_b32 s41, s41, 13
    s_add_u32 s40, s40, s41
    s_lshl_b32 s41, s16, 10
    s_add_u32 s40, s40, s41
    s_add_u32 s40, s40, 0x10000
    s_add_u32 s41, s40, 0x20000
    s_add_u32 s42, s40, 4096
    v_and_b32 v30, 0x1ff, v2
    v_bfe_u32 v31, v0, 4, 1
    v_lshl_add_u32 v30, v31, 17, v30
    s_lshl_b32 s43, s19, 2
    s_add_u32 s43, s43, s16
    s_lshl_b32 s43, s43, 7
    s_lshr_b32 s36, s18, 2
    s_lshl_b32 s36, s36, 2
    s_add_u32 s43, s43, s36
    s_add_u32 s43, s43, 0x6000
    s_waitcnt lgkmcnt(4)
    buffer_store_dwordx4 v[32:35], v1, s[8:11], s40 offen sc1
    s_waitcnt lgkmcnt(3)
    buffer_store_dwordx4 v[36:39], v1, s[8:11], s41 offen sc1
    s_waitcnt lgkmcnt(2)
    buffer_store_dwordx4 v[40:43], v30, s[8:11], s42 offen offset:0 sc1
    s_waitcnt lgkmcnt(1)
    buffer_store_dwordx4 v[44:47], v30, s[8:11], s42 offen offset:512 sc1
    s_waitcnt lgkmcnt(0)
    s_cmp_ge_u32 s18, 3
    s_cbranch_scc1 mega_kernel_nagd
    buffer_store_dwordx4 v[52:55], v20, s[4:7], s99 offen sc1
mega_kernel_nagd:
    v_mov_b32 v8, 1
    s_mov_b64 exec, 1
    s_waitcnt vmcnt(0)
    buffer_store_dword v8, off, s[8:11], s43 sc1
    s_mov_b64 exec, -1
    buffer_atomic_add v19, v14, s[8:11], 0 offen sc1
    s_branch mega_kernel_att
mega_kernel_qkv0_c:
    v_lshrrev_b32 v14, 4, v0
    v_xor_b32 v14, v14, v0
    v_and_b32 v14, 7, v14
    v_lshlrev_b32 v14, 4, v14
    v_lshrrev_b32 v15, 3, v0
    v_lshl_add_u32 v14, v15, 10, v14
    v_xor_b32 v15, 64, v14
    v_add_u32 v15, 7168, v15
    v_add_u32 v16, 14336, v14
    v_add_u32 v17, 14336, v15
    s_lshl_b32 s38, s18, 15
    s_lshl_b32 s37, s33, 8
    s_add_u32 s38, s38, s37
    s_lshl_b32 s39, s16, 12
    s_add_u32 s39, s39, 65536
    s_mov_b32 m0, s39
    s_nop 0
    buffer_load_dwordx4 v14, s[64:67], s38 offen offset:0 lds
    buffer_load_dwordx4 v15, s[64:67], s38 offen offset:1024 lds
    buffer_load_dwordx4 v16, s[64:67], s38 offen offset:2048 lds
    buffer_load_dwordx4 v17, s[64:67], s38 offen offset:3072 lds
    s_add_u32 m0, m0, 16384
    s_add_u32 s38, s38, 128
    buffer_load_dwordx4 v14, s[64:67], s38 offen offset:0 lds
    buffer_load_dwordx4 v15, s[64:67], s38 offen offset:1024 lds
    buffer_load_dwordx4 v16, s[64:67], s38 offen offset:2048 lds
    buffer_load_dwordx4 v17, s[64:67], s38 offen offset:3072 lds
    s_add_u32 m0, m0, 16384
    s_add_u32 s38, s38, 128
    s_bitset0_b32 s38, 10
    buffer_load_dwordx4 v14, s[64:67], s38 offen offset:0 lds
    buffer_load_dwordx4 v15, s[64:67], s38 offen offset:1024 lds
    buffer_load_dwordx4 v16, s[64:67], s38 offen offset:2048 lds
    buffer_load_dwordx4 v17, s[64:67], s38 offen offset:3072 lds
    s_add_u32 m0, m0, 16384
    s_add_u32 s38, s38, 128
    buffer_load_dwordx4 v14, s[64:67], s38 offen offset:0 lds
    buffer_load_dwordx4 v15, s[64:67], s38 offen offset:1024 lds
    buffer_load_dwordx4 v16, s[64:67], s38 offen offset:2048 lds
    buffer_load_dwordx4 v17, s[64:67], s38 offen offset:3072 lds
    s_add_u32 m0, m0, 16384
    s_add_u32 s38, s38, 128
    s_bitset0_b32 s38, 10
    buffer_load_dwordx4 v14, s[64:67], s38 offen offset:0 lds
    buffer_load_dwordx4 v15, s[64:67], s38 offen offset:1024 lds
    buffer_load_dwordx4 v16, s[64:67], s38 offen offset:2048 lds
    buffer_load_dwordx4 v17, s[64:67], s38 offen offset:3072 lds
    s_add_u32 m0, m0, 16384
    s_add_u32 s38, s38, 128
    buffer_load_dwordx4 v14, s[64:67], s38 offen offset:0 lds
    buffer_load_dwordx4 v15, s[64:67], s38 offen offset:1024 lds
    buffer_load_dwordx4 v16, s[64:67], s38 offen offset:2048 lds
    buffer_load_dwordx4 v17, s[64:67], s38 offen offset:3072 lds
    s_add_u32 m0, m0, 16384
    s_add_u32 s38, s38, 128
    s_bitset0_b32 s38, 10
    v_bfe_u32 v8, v0, 1, 3
    v_xor_b32 v8, v8, v10
    v_lshlrev_b32 v8, 4, v8
    v_and_b32 v9, 31, v0
    v_lshl_add_u32 v8, v9, 7, v8
    v_add_u32 v18, s39, v8
    v_xor_b32 v19, 32, v18
    v_xor_b32 v20, 64, v18
    v_xor_b32 v21, 96, v18
    v_lshl_add_u32 v22, v10, 9, v22
    v_add_u32 v23, 98304, v22
    s_lshl_b32 s48, s19, 6
    s_lshl_b32 s46, s33, 1
    s_add_u32 s46, s46, s16
    s_and_b32 s46, s46, 7
    s_xor_b32 s47, s46, 4
    s_mul_i32 s46, s46, 196608
    s_mul_i32 s47, s47, 196608
    s_add_u32 s46, s46, s48
    s_add_u32 s47, s47, s48
    s_mul_i32 s44, s18, 114688
    s_lshl_b32 s45, s19, 11
    s_add_u32 s44, s44, s45
    s_add_u32 s44, s44, 0x240000
    s_add_u32 s40, s44, 0x8000
    s_add_u32 s42, s44, 0x10000
    v_and_b32 v30, 0x1ff, v2
    v_bfe_u32 v31, v0, 4, 1
    v_lshl_add_u32 v30, v31, 10, v30
    s_lshl_b32 s43, s12, 4
    s_add_u32 s43, s43, s19
    s_lshl_b32 s43, s43, 7
    s_and_b32 s36, s18, 7
    s_lshl_b32 s36, s36, 2
    s_add_u32 s43, s43, s36
    s_add_u32 s43, s43, 0x2000
    v_add_u32 v31, s39, v1
    s_waitcnt vmcnt(16) lgkmcnt(0)
    ds_read_b128 v[128:131], v18 offset:0
    ds_read_b128 v[132:135], v19 offset:0
    ds_read_b128 v[136:139], v20 offset:0
    ds_read_b128 v[140:143], v21 offset:0
    ds_read_b128 v[144:147], v18 offset:16384
    ds_read_b128 v[148:151], v19 offset:16384
    ds_read_b128 v[152:155], v20 offset:16384
    ds_read_b128 v[156:159], v21 offset:16384
    s_waitcnt lgkmcnt(7)
    v_dot2_f32_bf16 v8, v128, v6, 0
    v_dot2_f32_bf16 v9, v128, v128, 0
    v_dot2_f32_bf16 v10, v129, v6, 0
    v_dot2_f32_bf16 v11, v129, v129, 0
    v_dot2_f32_bf16 v8, v130, v6, v8
    v_dot2_f32_bf16 v9, v130, v130, v9
    v_dot2_f32_bf16 v10, v131, v6, v10
    v_dot2_f32_bf16 v11, v131, v131, v11
    s_waitcnt lgkmcnt(6)
    v_dot2_f32_bf16 v8, v132, v6, v8
    v_dot2_f32_bf16 v9, v132, v132, v9
    v_dot2_f32_bf16 v10, v133, v6, v10
    v_dot2_f32_bf16 v11, v133, v133, v11
    v_dot2_f32_bf16 v8, v134, v6, v8
    v_dot2_f32_bf16 v9, v134, v134, v9
    v_dot2_f32_bf16 v10, v135, v6, v10
    v_dot2_f32_bf16 v11, v135, v135, v11
    s_waitcnt lgkmcnt(5)
    v_dot2_f32_bf16 v8, v136, v6, v8
    v_dot2_f32_bf16 v9, v136, v136, v9
    v_dot2_f32_bf16 v10, v137, v6, v10
    v_dot2_f32_bf16 v11, v137, v137, v11
    v_dot2_f32_bf16 v8, v138, v6, v8
    v_dot2_f32_bf16 v9, v138, v138, v9
    v_dot2_f32_bf16 v10, v139, v6, v10
    v_dot2_f32_bf16 v11, v139, v139, v11
    s_waitcnt lgkmcnt(4)
    v_dot2_f32_bf16 v8, v140, v6, v8
    v_dot2_f32_bf16 v9, v140, v140, v9
    v_dot2_f32_bf16 v10, v141, v6, v10
    v_dot2_f32_bf16 v11, v141, v141, v11
    v_dot2_f32_bf16 v8, v142, v6, v8
    v_dot2_f32_bf16 v9, v142, v142, v9
    v_dot2_f32_bf16 v10, v143, v6, v10
    v_dot2_f32_bf16 v11, v143, v143, v11
    s_waitcnt lgkmcnt(3)
    v_dot2_f32_bf16 v8, v144, v6, v8
    v_dot2_f32_bf16 v9, v144, v144, v9
    v_dot2_f32_bf16 v10, v145, v6, v10
    v_dot2_f32_bf16 v11, v145, v145, v11
    v_dot2_f32_bf16 v8, v146, v6, v8
    v_dot2_f32_bf16 v9, v146, v146, v9
    v_dot2_f32_bf16 v10, v147, v6, v10
    v_dot2_f32_bf16 v11, v147, v147, v11
    s_waitcnt lgkmcnt(2)
    v_dot2_f32_bf16 v8, v148, v6, v8
    v_dot2_f32_bf16 v9, v148, v148, v9
    v_dot2_f32_bf16 v10, v149, v6, v10
    v_dot2_f32_bf16 v11, v149, v149, v11
    v_dot2_f32_bf16 v8, v150, v6, v8
    v_dot2_f32_bf16 v9, v150, v150, v9
    v_dot2_f32_bf16 v10, v151, v6, v10
    v_dot2_f32_bf16 v11, v151, v151, v11
    s_waitcnt lgkmcnt(1)
    v_dot2_f32_bf16 v8, v152, v6, v8
    v_dot2_f32_bf16 v9, v152, v152, v9
    v_dot2_f32_bf16 v10, v153, v6, v10
    v_dot2_f32_bf16 v11, v153, v153, v11
    v_dot2_f32_bf16 v8, v154, v6, v8
    v_dot2_f32_bf16 v9, v154, v154, v9
    v_dot2_f32_bf16 v10, v155, v6, v10
    v_dot2_f32_bf16 v11, v155, v155, v11
    s_waitcnt lgkmcnt(0)
    v_dot2_f32_bf16 v8, v156, v6, v8
    v_dot2_f32_bf16 v9, v156, v156, v9
    v_dot2_f32_bf16 v10, v157, v6, v10
    v_dot2_f32_bf16 v11, v157, v157, v11
    v_dot2_f32_bf16 v8, v158, v6, v8
    v_dot2_f32_bf16 v9, v158, v158, v9
    v_dot2_f32_bf16 v10, v159, v6, v10
    v_dot2_f32_bf16 v11, v159, v159, v11
    s_waitcnt vmcnt(8)
    ds_read_b128 v[160:163], v18 offset:32768
    ds_read_b128 v[164:167], v19 offset:32768
    ds_read_b128 v[168:171], v20 offset:32768
    ds_read_b128 v[172:175], v21 offset:32768
    ds_read_b128 v[176:179], v18 offset:49152
    ds_read_b128 v[180:183], v19 offset:49152
    ds_read_b128 v[184:187], v20 offset:49152
    ds_read_b128 v[188:191], v21 offset:49152
    s_waitcnt lgkmcnt(7)
    v_dot2_f32_bf16 v8, v160, v6, v8
    v_dot2_f32_bf16 v9, v160, v160, v9
    v_dot2_f32_bf16 v10, v161, v6, v10
    v_dot2_f32_bf16 v11, v161, v161, v11
    v_dot2_f32_bf16 v8, v162, v6, v8
    v_dot2_f32_bf16 v9, v162, v162, v9
    v_dot2_f32_bf16 v10, v163, v6, v10
    v_dot2_f32_bf16 v11, v163, v163, v11
    s_waitcnt lgkmcnt(6)
    v_dot2_f32_bf16 v8, v164, v6, v8
    v_dot2_f32_bf16 v9, v164, v164, v9
    v_dot2_f32_bf16 v10, v165, v6, v10
    v_dot2_f32_bf16 v11, v165, v165, v11
    v_dot2_f32_bf16 v8, v166, v6, v8
    v_dot2_f32_bf16 v9, v166, v166, v9
    v_dot2_f32_bf16 v10, v167, v6, v10
    v_dot2_f32_bf16 v11, v167, v167, v11
    s_waitcnt lgkmcnt(5)
    v_dot2_f32_bf16 v8, v168, v6, v8
    v_dot2_f32_bf16 v9, v168, v168, v9
    v_dot2_f32_bf16 v10, v169, v6, v10
    v_dot2_f32_bf16 v11, v169, v169, v11
    v_dot2_f32_bf16 v8, v170, v6, v8
    v_dot2_f32_bf16 v9, v170, v170, v9
    v_dot2_f32_bf16 v10, v171, v6, v10
    v_dot2_f32_bf16 v11, v171, v171, v11
    s_waitcnt lgkmcnt(4)
    v_dot2_f32_bf16 v8, v172, v6, v8
    v_dot2_f32_bf16 v9, v172, v172, v9
    v_dot2_f32_bf16 v10, v173, v6, v10
    v_dot2_f32_bf16 v11, v173, v173, v11
    v_dot2_f32_bf16 v8, v174, v6, v8
    v_dot2_f32_bf16 v9, v174, v174, v9
    v_dot2_f32_bf16 v10, v175, v6, v10
    v_dot2_f32_bf16 v11, v175, v175, v11
    s_waitcnt lgkmcnt(3)
    v_dot2_f32_bf16 v8, v176, v6, v8
    v_dot2_f32_bf16 v9, v176, v176, v9
    v_dot2_f32_bf16 v10, v177, v6, v10
    v_dot2_f32_bf16 v11, v177, v177, v11
    v_dot2_f32_bf16 v8, v178, v6, v8
    v_dot2_f32_bf16 v9, v178, v178, v9
    v_dot2_f32_bf16 v10, v179, v6, v10
    v_dot2_f32_bf16 v11, v179, v179, v11
    s_waitcnt lgkmcnt(2)
    v_dot2_f32_bf16 v8, v180, v6, v8
    v_dot2_f32_bf16 v9, v180, v180, v9
    v_dot2_f32_bf16 v10, v181, v6, v10
    v_dot2_f32_bf16 v11, v181, v181, v11
    v_dot2_f32_bf16 v8, v182, v6, v8
    v_dot2_f32_bf16 v9, v182, v182, v9
    v_dot2_f32_bf16 v10, v183, v6, v10
    v_dot2_f32_bf16 v11, v183, v183, v11
    s_waitcnt lgkmcnt(1)
    v_dot2_f32_bf16 v8, v184, v6, v8
    v_dot2_f32_bf16 v9, v184, v184, v9
    v_dot2_f32_bf16 v10, v185, v6, v10
    v_dot2_f32_bf16 v11, v185, v185, v11
    v_dot2_f32_bf16 v8, v186, v6, v8
    v_dot2_f32_bf16 v9, v186, v186, v9
    v_dot2_f32_bf16 v10, v187, v6, v10
    v_dot2_f32_bf16 v11, v187, v187, v11
    s_waitcnt lgkmcnt(0)
    v_dot2_f32_bf16 v8, v188, v6, v8
    v_dot2_f32_bf16 v9, v188, v188, v9
    v_dot2_f32_bf16 v10, v189, v6, v10
    v_dot2_f32_bf16 v11, v189, v189, v11
    v_dot2_f32_bf16 v8, v190, v6, v8
    v_dot2_f32_bf16 v9, v190, v190, v9
    v_dot2_f32_bf16 v10, v191, v6, v10
    v_dot2_f32_bf16 v11, v191, v191, v11
    v_add_u32 v18, 0x10000, v18
    v_add_u32 v19, 0x10000, v19
    v_add_u32 v20, 0x10000, v20
    v_add_u32 v21, 0x10000, v21
    s_waitcnt vmcnt(0)
    ds_read_b128 v[192:195], v18 offset:0
    ds_read_b128 v[196:199], v19 offset:0
    ds_read_b128 v[200:203], v20 offset:0
    ds_read_b128 v[204:207], v21 offset:0
    ds_read_b128 v[208:211], v18 offset:16384
    ds_read_b128 v[212:215], v19 offset:16384
    ds_read_b128 v[216:219], v20 offset:16384
    ds_read_b128 v[220:223], v21 offset:16384
    s_waitcnt lgkmcnt(7)
    v_dot2_f32_bf16 v8, v192, v6, v8
    v_dot2_f32_bf16 v9, v192, v192, v9
    v_dot2_f32_bf16 v10, v193, v6, v10
    v_dot2_f32_bf16 v11, v193, v193, v11
    v_dot2_f32_bf16 v8, v194, v6, v8
    v_dot2_f32_bf16 v9, v194, v194, v9
    v_dot2_f32_bf16 v10, v195, v6, v10
    v_dot2_f32_bf16 v11, v195, v195, v11
    s_waitcnt lgkmcnt(6)
    v_dot2_f32_bf16 v8, v196, v6, v8
    v_dot2_f32_bf16 v9, v196, v196, v9
    v_dot2_f32_bf16 v10, v197, v6, v10
    v_dot2_f32_bf16 v11, v197, v197, v11
    v_dot2_f32_bf16 v8, v198, v6, v8
    v_dot2_f32_bf16 v9, v198, v198, v9
    v_dot2_f32_bf16 v10, v199, v6, v10
    v_dot2_f32_bf16 v11, v199, v199, v11
    s_waitcnt lgkmcnt(5)
    v_dot2_f32_bf16 v8, v200, v6, v8
    v_dot2_f32_bf16 v9, v200, v200, v9
    v_dot2_f32_bf16 v10, v201, v6, v10
    v_dot2_f32_bf16 v11, v201, v201, v11
    v_dot2_f32_bf16 v8, v202, v6, v8
    v_dot2_f32_bf16 v9, v202, v202, v9
    v_dot2_f32_bf16 v10, v203, v6, v10
    v_dot2_f32_bf16 v11, v203, v203, v11
    s_waitcnt lgkmcnt(4)
    v_dot2_f32_bf16 v8, v204, v6, v8
    v_dot2_f32_bf16 v9, v204, v204, v9
    v_dot2_f32_bf16 v10, v205, v6, v10
    v_dot2_f32_bf16 v11, v205, v205, v11
    v_dot2_f32_bf16 v8, v206, v6, v8
    v_dot2_f32_bf16 v9, v206, v206, v9
    v_dot2_f32_bf16 v10, v207, v6, v10
    v_dot2_f32_bf16 v11, v207, v207, v11
    s_waitcnt lgkmcnt(3)
    v_dot2_f32_bf16 v8, v208, v6, v8
    v_dot2_f32_bf16 v9, v208, v208, v9
    v_dot2_f32_bf16 v10, v209, v6, v10
    v_dot2_f32_bf16 v11, v209, v209, v11
    v_dot2_f32_bf16 v8, v210, v6, v8
    v_dot2_f32_bf16 v9, v210, v210, v9
    v_dot2_f32_bf16 v10, v211, v6, v10
    v_dot2_f32_bf16 v11, v211, v211, v11
    s_waitcnt lgkmcnt(2)
    v_dot2_f32_bf16 v8, v212, v6, v8
    v_dot2_f32_bf16 v9, v212, v212, v9
    v_dot2_f32_bf16 v10, v213, v6, v10
    v_dot2_f32_bf16 v11, v213, v213, v11
    v_dot2_f32_bf16 v8, v214, v6, v8
    v_dot2_f32_bf16 v9, v214, v214, v9
    v_dot2_f32_bf16 v10, v215, v6, v10
    v_dot2_f32_bf16 v11, v215, v215, v11
    s_waitcnt lgkmcnt(1)
    v_dot2_f32_bf16 v8, v216, v6, v8
    v_dot2_f32_bf16 v9, v216, v216, v9
    v_dot2_f32_bf16 v10, v217, v6, v10
    v_dot2_f32_bf16 v11, v217, v217, v11
    v_dot2_f32_bf16 v8, v218, v6, v8
    v_dot2_f32_bf16 v9, v218, v218, v9
    v_dot2_f32_bf16 v10, v219, v6, v10
    v_dot2_f32_bf16 v11, v219, v219, v11
    s_waitcnt lgkmcnt(0)
    v_dot2_f32_bf16 v8, v220, v6, v8
    v_dot2_f32_bf16 v9, v220, v220, v9
    v_dot2_f32_bf16 v10, v221, v6, v10
    v_dot2_f32_bf16 v11, v221, v221, v11
    v_dot2_f32_bf16 v8, v222, v6, v8
    v_dot2_f32_bf16 v9, v222, v222, v9
    v_dot2_f32_bf16 v10, v223, v6, v10
    v_dot2_f32_bf16 v11, v223, v223, v11
    s_barrier
    ds_read_b64_tr_b16 v[32:33], v22 offset:0
    ds_read_b64_tr_b16 v[34:35], v22 offset:256
    ds_read_b64_tr_b16 v[36:37], v22 offset:1024
    ds_read_b64_tr_b16 v[38:39], v22 offset:1280
    ds_read_b64_tr_b16 v[40:41], v22 offset:2048
    ds_read_b64_tr_b16 v[42:43], v22 offset:2304
    ds_read_b64_tr_b16 v[44:45], v22 offset:3072
    ds_read_b64_tr_b16 v[46:47], v22 offset:3328
    ds_read_b64_tr_b16 v[48:49], v22 offset:4096
    ds_read_b64_tr_b16 v[50:51], v22 offset:4352
    ds_read_b64_tr_b16 v[52:53], v22 offset:5120
    ds_read_b64_tr_b16 v[54:55], v22 offset:5376
    s_waitcnt lgkmcnt(10)
    v_mfma_f32_32x32x16_bf16 v[64:79], v[32:35], v[128:131], 0
    s_mov_b32 m0, s39
    s_nop 0
    buffer_load_dwordx4 v14, s[64:67], s38 offen offset:0 lds
    buffer_load_dwordx4 v15, s[64:67], s38 offen offset:1024 lds
    buffer_load_dwordx4 v16, s[64:67], s38 offen offset:2048 lds
    buffer_load_dwordx4 v17, s[64:67], s38 offen offset:3072 lds
    s_add_u32 m0, m0, 16384
    s_add_u32 s38, s38, 128
    buffer_load_dwordx4 v14, s[64:67], s38 offen offset:0 lds
    buffer_load_dwordx4 v15, s[64:67], s38 offen offset:1024 lds
    buffer_load_dwordx4 v16, s[64:67], s38 offen offset:2048 lds
    buffer_load_dwordx4 v17, s[64:67], s38 offen offset:3072 lds
    s_add_u32 m0, m0, 16384
    s_add_u32 s38, s38, 128
    s_bitset0_b32 s38, 10
    v_add_u32 v17, 131072, v2
    ds_read_b64_tr_b16 v[56:57], v22 offset:6144
    ds_read_b64_tr_b16 v[58:59], v22 offset:6400
    s_waitcnt lgkmcnt(10)
    v_mfma_f32_32x32x16_bf16 v[80:95], v[128:131], v[36:39], 0
    ds_read_b64_tr_b16 v[60:61], v22 offset:7168
    ds_read_b64_tr_b16 v[62:63], v22 offset:7424
    s_waitcnt lgkmcnt(10)
    v_mfma_f32_32x32x16_bf16 v[64:79], v[40:43], v[132:135], v[64:79]
    ds_read_b64_tr_b16 v[32:33], v22 offset:8192
    ds_read_b64_tr_b16 v[34:35], v22 offset:8448
    s_waitcnt lgkmcnt(10)
    v_mfma_f32_32x32x16_bf16 v[80:95], v[132:135], v[44:47], v[80:95]
    ds_read_b64_tr_b16 v[36:37], v22 offset:9216
    ds_read_b64_tr_b16 v[38:39], v22 offset:9472
    s_waitcnt lgkmcnt(10)
    v_mfma_f32_32x32x16_bf16 v[64:79], v[48:51], v[136:139], v[64:79]
    ds_read_b64_tr_b16 v[40:41], v22 offset:10240
    ds_read_b64_tr_b16 v[42:43], v22 offset:10496
    s_waitcnt lgkmcnt(10)
    v_mfma_f32_32x32x16_bf16 v[80:95], v[136:139], v[52:55], v[80:95]
    ds_read_b64_tr_b16 v[44:45], v22 offset:11264
    ds_read_b64_tr_b16 v[46:47], v22 offset:11520
    s_waitcnt lgkmcnt(10)
    v_mfma_f32_32x32x16_bf16 v[64:79], v[56:59], v[140:143], v[64:79]
    ds_read_b64_tr_b16 v[48:49], v22 offset:12288
    ds_read_b64_tr_b16 v[50:51], v22 offset:12544
    s_waitcnt lgkmcnt(10)
    v_mfma_f32_32x32x16_bf16 v[80:95], v[140:143], v[60:63], v[80:95]
    ds_read_b64_tr_b16 v[52:53], v22 offset:13312
    ds_read_b64_tr_b16 v[54:55], v22 offset:13568
    s_waitcnt lgkmcnt(10)
    v_mfma_f32_32x32x16_bf16 v[64:79], v[32:35], v[144:147], v[64:79]
    ds_read_b64_tr_b16 v[56:57], v22 offset:14336
    ds_read_b64_tr_b16 v[58:59], v22 offset:14592
    s_waitcnt lgkmcnt(10)
    v_mfma_f32_32x32x16_bf16 v[80:95], v[144:147], v[36:39], v[80:95]
    ds_read_b64_tr_b16 v[60:61], v22 offset:15360
    ds_read_b64_tr_b16 v[62:63], v22 offset:15616
    s_waitcnt lgkmcnt(10)
    v_mfma_f32_32x32x16_bf16 v[64:79], v[40:43], v[148:151], v[64:79]
    s_barrier
    ds_read_b64_tr_b16 v[32:33], v22 offset:16384
    ds_read_b64_tr_b16 v[34:35], v22 offset:16640
    s_waitcnt lgkmcnt(10)
    v_mfma_f32_32x32x16_bf16 v[80:95], v[148:151], v[44:47], v[80:95]
    ds_read_b64_tr_b16 v[36:37], v22 offset:17408
    ds_read_b64_tr_b16 v[38:39], v22 offset:17664
    s_waitcnt lgkmcnt(10)
    v_mfma_f32_32x32x16_bf16 v[64:79], v[48:51], v[152:155], v[64:79]
    ds_read_b64_tr_b16 v[40:41], v22 offset:18432
    ds_read_b64_tr_b16 v[42:43], v22 offset:18688
    s_waitcnt lgkmcnt(10)
    v_mfma_f32_32x32x16_bf16 v[80:95], v[152:155], v[52:55], v[80:95]
    ds_read_b64_tr_b16 v[44:45], v22 offset:19456
    ds_read_b64_tr_b16 v[46:47], v22 offset:19712
    s_waitcnt lgkmcnt(10)
    v_mfma_f32_32x32x16_bf16 v[64:79], v[56:59], v[156:159], v[64:79]
    ds_read_b64_tr_b16 v[48:49], v22 offset:20480
    ds_read_b64_tr_b16 v[50:51], v22 offset:20736
    s_waitcnt lgkmcnt(10)
    v_mfma_f32_32x32x16_bf16 v[80:95], v[156:159], v[60:63], v[80:95]
    ds_read_b64_tr_b16 v[52:53], v22 offset:21504
    ds_read_b64_tr_b16 v[54:55], v22 offset:21760
    s_waitcnt lgkmcnt(10)
    v_mfma_f32_32x32x16_bf16 v[64:79], v[32:35], v[160:163], v[64:79]
    ds_read_b64_tr_b16 v[56:57], v22 offset:22528
    ds_read_b64_tr_b16 v[58:59], v22 offset:22784
    s_waitcnt lgkmcnt(10)
    v_mfma_f32_32x32x16_bf16 v[80:95], v[160:163], v[36:39], v[80:95]
    ds_read_b64_tr_b16 v[60:61], v22 offset:23552
    ds_read_b64_tr_b16 v[62:63], v22 offset:23808
    s_waitcnt lgkmcnt(10)
    v_mfma_f32_32x32x16_bf16 v[64:79], v[40:43], v[164:167], v[64:79]
    ds_read_b64_tr_b16 v[32:33], v22 offset:24576
    ds_read_b64_tr_b16 v[34:35], v22 offset:24832
    s_waitcnt lgkmcnt(10)
    v_mfma_f32_32x32x16_bf16 v[80:95], v[164:167], v[44:47], v[80:95]
    ds_read_b64_tr_b16 v[36:37], v22 offset:25600
    ds_read_b64_tr_b16 v[38:39], v22 offset:25856
    s_waitcnt lgkmcnt(10)
    v_mfma_f32_32x32x16_bf16 v[64:79], v[48:51], v[168:171], v[64:79]
    ds_read_b64_tr_b16 v[40:41], v22 offset:26624
    ds_read_b64_tr_b16 v[42:43], v22 offset:26880
    s_waitcnt lgkmcnt(10)
    v_mfma_f32_32x32x16_bf16 v[80:95], v[168:171], v[52:55], v[80:95]
    ds_read_b64_tr_b16 v[44:45], v22 offset:27648
    ds_read_b64_tr_b16 v[46:47], v22 offset:27904
    s_waitcnt lgkmcnt(10)
    v_mfma_f32_32x32x16_bf16 v[64:79], v[56:59], v[172:175], v[64:79]
    ds_read_b64_tr_b16 v[48:49], v22 offset:28672
    ds_read_b64_tr_b16 v[50:51], v22 offset:28928
    s_waitcnt lgkmcnt(10)
    v_mfma_f32_32x32x16_bf16 v[80:95], v[172:175], v[60:63], v[80:95]
    ds_read_b64_tr_b16 v[52:53], v22 offset:29696
    ds_read_b64_tr_b16 v[54:55], v22 offset:29952
    s_waitcnt lgkmcnt(10)
    v_mfma_f32_32x32x16_bf16 v[64:79], v[32:35], v[176:179], v[64:79]
    ds_read_b64_tr_b16 v[56:57], v22 offset:30720
    ds_read_b64_tr_b16 v[58:59], v22 offset:30976
    s_waitcnt lgkmcnt(10)
    v_mfma_f32_32x32x16_bf16 v[80:95], v[176:179], v[36:39], v[80:95]
    ds_read_b64_tr_b16 v[60:61], v22 offset:31744
    ds_read_b64_tr_b16 v[62:63], v22 offset:32000
    s_waitcnt lgkmcnt(10)
    v_mfma_f32_32x32x16_bf16 v[64:79], v[40:43], v[180:183], v[64:79]
    s_barrier
    ds_read_b64_tr_b16 v[32:33], v22 offset:32768
    ds_read_b64_tr_b16 v[34:35], v22 offset:33024
    s_waitcnt lgkmcnt(10)
    v_mfma_f32_32x32x16_bf16 v[80:95], v[180:183], v[44:47], v[80:95]
    ds_read_b64_tr_b16 v[36:37], v22 offset:33792
    ds_read_b64_tr_b16 v[38:39], v22 offset:34048
    s_waitcnt lgkmcnt(10)
    v_mfma_f32_32x32x16_bf16 v[64:79], v[48:51], v[184:187], v[64:79]
    ds_read_b64_tr_b16 v[40:41], v22 offset:34816
    ds_read_b64_tr_b16 v[42:43], v22 offset:35072
    s_waitcnt lgkmcnt(10)
    v_mfma_f32_32x32x16_bf16 v[80:95], v[184:187], v[52:55], v[80:95]
    ds_read_b64_tr_b16 v[44:45], v22 offset:35840
    ds_read_b64_tr_b16 v[46:47], v22 offset:36096
    s_waitcnt lgkmcnt(10)
    v_mfma_f32_32x32x16_bf16 v[64:79], v[56:59], v[188:191], v[64:79]
    ds_read_b64_tr_b16 v[48:49], v22 offset:36864
    ds_read_b64_tr_b16 v[50:51], v22 offset:37120
    s_waitcnt lgkmcnt(10)
    v_mfma_f32_32x32x16_bf16 v[80:95], v[188:191], v[60:63], v[80:95]
    ds_read_b64_tr_b16 v[52:53], v22 offset:37888
    ds_read_b64_tr_b16 v[54:55], v22 offset:38144
    s_waitcnt lgkmcnt(10)
    v_mfma_f32_32x32x16_bf16 v[64:79], v[32:35], v[192:195], v[64:79]
    ds_read_b64_tr_b16 v[56:57], v22 offset:38912
    ds_read_b64_tr_b16 v[58:59], v22 offset:39168
    s_waitcnt lgkmcnt(10)
    v_mfma_f32_32x32x16_bf16 v[80:95], v[192:195], v[36:39], v[80:95]
    ds_read_b64_tr_b16 v[60:61], v22 offset:39936
    ds_read_b64_tr_b16 v[62:63], v22 offset:40192
    s_waitcnt lgkmcnt(10)
    v_mfma_f32_32x32x16_bf16 v[64:79], v[40:43], v[196:199], v[64:79]
    ds_read_b64_tr_b16 v[32:33], v22 offset:40960
    ds_read_b64_tr_b16 v[34:35], v22 offset:41216
    s_waitcnt lgkmcnt(10)
    v_mfma_f32_32x32x16_bf16 v[80:95], v[196:199], v[44:47], v[80:95]
    ds_read_b64_tr_b16 v[36:37], v22 offset:41984
    ds_read_b64_tr_b16 v[38:39], v22 offset:42240
    s_waitcnt lgkmcnt(10)
    v_mfma_f32_32x32x16_bf16 v[64:79], v[48:51], v[200:203], v[64:79]
    ds_read_b64_tr_b16 v[40:41], v22 offset:43008
    ds_read_b64_tr_b16 v[42:43], v22 offset:43264
    s_waitcnt lgkmcnt(10)
    v_mfma_f32_32x32x16_bf16 v[80:95], v[200:203], v[52:55], v[80:95]
    ds_read_b64_tr_b16 v[44:45], v22 offset:44032
    ds_read_b64_tr_b16 v[46:47], v22 offset:44288
    s_waitcnt lgkmcnt(10)
    v_mfma_f32_32x32x16_bf16 v[64:79], v[56:59], v[204:207], v[64:79]
    ds_read_b64_tr_b16 v[48:49], v22 offset:45056
    ds_read_b64_tr_b16 v[50:51], v22 offset:45312
    s_waitcnt lgkmcnt(10)
    v_mfma_f32_32x32x16_bf16 v[80:95], v[204:207], v[60:63], v[80:95]
    ds_read_b64_tr_b16 v[52:53], v22 offset:46080
    ds_read_b64_tr_b16 v[54:55], v22 offset:46336
    s_waitcnt lgkmcnt(10)
    v_mfma_f32_32x32x16_bf16 v[64:79], v[32:35], v[208:211], v[64:79]
    ds_read_b64_tr_b16 v[56:57], v22 offset:47104
    ds_read_b64_tr_b16 v[58:59], v22 offset:47360
    s_waitcnt lgkmcnt(10)
    v_mfma_f32_32x32x16_bf16 v[80:95], v[208:211], v[36:39], v[80:95]
    ds_read_b64_tr_b16 v[60:61], v22 offset:48128
    ds_read_b64_tr_b16 v[62:63], v22 offset:48384
    s_waitcnt lgkmcnt(10)
    v_mfma_f32_32x32x16_bf16 v[64:79], v[40:43], v[212:215], v[64:79]
    v_add_u32 v18, 0xffff0000, v18
    v_add_u32 v19, 0xffff0000, v19
    v_add_u32 v20, 0xffff0000, v20
    v_add_u32 v21, 0xffff0000, v21
    s_waitcnt vmcnt(0)
    ds_read_b128 v[224:227], v18 offset:0
    ds_read_b128 v[228:231], v19 offset:0
    ds_read_b128 v[232:235], v20 offset:0
    ds_read_b128 v[236:239], v21 offset:0
    ds_read_b128 v[240:243], v18 offset:16384
    ds_read_b128 v[244:247], v19 offset:16384
    ds_read_b128 v[248:251], v20 offset:16384
    ds_read_b128 v[252:255], v21 offset:16384
    s_barrier
    ds_read_b64_tr_b16 v[32:33], v22 offset:49152
    ds_read_b64_tr_b16 v[34:35], v22 offset:49408
    s_waitcnt lgkmcnt(15)
    v_mfma_f32_32x32x16_bf16 v[80:95], v[212:215], v[44:47], v[80:95]
    ds_read_b64_tr_b16 v[36:37], v22 offset:50176
    ds_read_b64_tr_b16 v[38:39], v22 offset:50432
    s_waitcnt lgkmcnt(15)
    v_mfma_f32_32x32x16_bf16 v[64:79], v[48:51], v[216:219], v[64:79]
    ds_read_b64_tr_b16 v[40:41], v22 offset:51200
    ds_read_b64_tr_b16 v[42:43], v22 offset:51456
    s_waitcnt lgkmcnt(15)
    v_mfma_f32_32x32x16_bf16 v[80:95], v[216:219], v[52:55], v[80:95]
    ds_read_b64_tr_b16 v[44:45], v22 offset:52224
    ds_read_b64_tr_b16 v[46:47], v22 offset:52480
    s_waitcnt lgkmcnt(15)
    v_mfma_f32_32x32x16_bf16 v[64:79], v[56:59], v[220:223], v[64:79]
    ds_read_b64_tr_b16 v[48:49], v22 offset:53248
    ds_read_b64_tr_b16 v[50:51], v22 offset:53504
    s_waitcnt lgkmcnt(15)
    v_mfma_f32_32x32x16_bf16 v[80:95], v[220:223], v[60:63], v[80:95]
    ds_read_b64_tr_b16 v[52:53], v22 offset:54272
    ds_read_b64_tr_b16 v[54:55], v22 offset:54528
    s_waitcnt lgkmcnt(10)
    v_mfma_f32_32x32x16_bf16 v[64:79], v[32:35], v[224:227], v[64:79]
    v_dot2_f32_bf16 v8, v224, v6, v8
    v_dot2_f32_bf16 v9, v224, v224, v9
    v_dot2_f32_bf16 v10, v225, v6, v10
    v_dot2_f32_bf16 v11, v225, v225, v11
    v_dot2_f32_bf16 v8, v226, v6, v8
    v_dot2_f32_bf16 v9, v226, v226, v9
    v_dot2_f32_bf16 v10, v227, v6, v10
    v_dot2_f32_bf16 v11, v227, v227, v11
    v_dot2_f32_bf16 v8, v228, v6, v8
    v_dot2_f32_bf16 v9, v228, v228, v9
    v_dot2_f32_bf16 v10, v229, v6, v10
    v_dot2_f32_bf16 v11, v229, v229, v11
    v_dot2_f32_bf16 v8, v230, v6, v8
    v_dot2_f32_bf16 v9, v230, v230, v9
    v_dot2_f32_bf16 v10, v231, v6, v10
    v_dot2_f32_bf16 v11, v231, v231, v11
    v_dot2_f32_bf16 v8, v232, v6, v8
    v_dot2_f32_bf16 v9, v232, v232, v9
    v_dot2_f32_bf16 v10, v233, v6, v10
    v_dot2_f32_bf16 v11, v233, v233, v11
    v_dot2_f32_bf16 v8, v234, v6, v8
    v_dot2_f32_bf16 v9, v234, v234, v9
    v_dot2_f32_bf16 v10, v235, v6, v10
    v_dot2_f32_bf16 v11, v235, v235, v11
    v_dot2_f32_bf16 v8, v236, v6, v8
    v_dot2_f32_bf16 v9, v236, v236, v9
    v_dot2_f32_bf16 v10, v237, v6, v10
    v_dot2_f32_bf16 v11, v237, v237, v11
    v_dot2_f32_bf16 v8, v238, v6, v8
    v_dot2_f32_bf16 v9, v238, v238, v9
    v_dot2_f32_bf16 v10, v239, v6, v10
    v_dot2_f32_bf16 v11, v239, v239, v11
    v_dot2_f32_bf16 v8, v240, v6, v8
    v_dot2_f32_bf16 v9, v240, v240, v9
    v_dot2_f32_bf16 v10, v241, v6, v10
    v_dot2_f32_bf16 v11, v241, v241, v11
    v_dot2_f32_bf16 v8, v242, v6, v8
    v_dot2_f32_bf16 v9, v242, v242, v9
    v_dot2_f32_bf16 v10, v243, v6, v10
    v_dot2_f32_bf16 v11, v243, v243, v11
    v_dot2_f32_bf16 v8, v244, v6, v8
    v_dot2_f32_bf16 v9, v244, v244, v9
    v_dot2_f32_bf16 v10, v245, v6, v10
    v_dot2_f32_bf16 v11, v245, v245, v11
    v_dot2_f32_bf16 v8, v246, v6, v8
    v_dot2_f32_bf16 v9, v246, v246, v9
    v_dot2_f32_bf16 v10, v247, v6, v10
    v_dot2_f32_bf16 v11, v247, v247, v11
    v_dot2_f32_bf16 v8, v248, v6, v8
    v_dot2_f32_bf16 v9, v248, v248, v9
    v_dot2_f32_bf16 v10, v249, v6, v10
    v_dot2_f32_bf16 v11, v249, v249, v11
    v_dot2_f32_bf16 v8, v250, v6, v8
    v_dot2_f32_bf16 v9, v250, v250, v9
    v_dot2_f32_bf16 v10, v251, v6, v10
    v_dot2_f32_bf16 v11, v251, v251, v11
    v_dot2_f32_bf16 v8, v252, v6, v8
    v_dot2_f32_bf16 v9, v252, v252, v9
    v_dot2_f32_bf16 v10, v253, v6, v10
    v_dot2_f32_bf16 v11, v253, v253, v11
    v_dot2_f32_bf16 v8, v254, v6, v8
    v_dot2_f32_bf16 v9, v254, v254, v9
    v_dot2_f32_bf16 v10, v255, v6, v10
    v_dot2_f32_bf16 v11, v255, v255, v11
    ds_read_b64_tr_b16 v[56:57], v22 offset:55296
    ds_read_b64_tr_b16 v[58:59], v22 offset:55552
    s_waitcnt lgkmcnt(10)
    v_mfma_f32_32x32x16_bf16 v[80:95], v[224:227], v[36:39], v[80:95]
    v_add_f32 v8, v8, v10
    v_add_f32 v9, v9, v11
    v_mov_b32 v10, v8
    v_mov_b32 v11, v9
    s_nop 0
    v_permlane32_swap_b32 v8, v10
    ds_read_b64_tr_b16 v[60:61], v22 offset:56320
    ds_read_b64_tr_b16 v[62:63], v22 offset:56576
    s_waitcnt lgkmcnt(10)
    v_mfma_f32_32x32x16_bf16 v[64:79], v[40:43], v[228:231], v[64:79]
    v_permlane32_swap_b32 v9, v11
    v_add_f32 v8, v8, v10
    v_add_f32 v9, v9, v11
    v_mul_f32 v8, 0xbb000000, v8
    v_mul_f32 v9, 0x3b000000, v9
    ds_read_b64_tr_b16 v[32:33], v22 offset:57344
    ds_read_b64_tr_b16 v[34:35], v22 offset:57600
    s_waitcnt lgkmcnt(10)
    v_mfma_f32_32x32x16_bf16 v[80:95], v[228:231], v[44:47], v[80:95]
    v_fma_f32 v9, -v8, v8, v9
    v_max_f32 v9, 0, v9
    v_add_f32 v9, 0x3727c5ac, v9
    v_rsq_f32 v28, v9
    v_cvt_pk_bf16_f32 v25, v8, 0
    ds_read_b64_tr_b16 v[36:37], v22 offset:58368
    ds_read_b64_tr_b16 v[38:39], v22 offset:58624
    s_waitcnt lgkmcnt(10)
    v_mfma_f32_32x32x16_bf16 v[64:79], v[48:51], v[232:235], v[64:79]
    v_lshlrev_b32 v13, 16, v25
    v_sub_f32 v13, v8, v13
    v_cvt_pk_bf16_f32 v24, v8, v13
    v_cvt_pk_bf16_f32 v26, v8, v13
    v_mov_b32 v27, v25
    ds_read_b64_tr_b16 v[40:41], v22 offset:59392
    ds_read_b64_tr_b16 v[42:43], v22 offset:59648
    s_waitcnt lgkmcnt(10)
    v_mfma_f32_32x32x16_bf16 v[80:95], v[232:235], v[52:55], v[80:95]
    s_lshl_b32 s36, s16, 7
    s_add_u32 s36, s36, 134144
    v_and_b32 v8, 31, v0
    v_lshl_add_u32 v8, v8, 2, s36
    v_lshrrev_b32 v9, 5, v0
    ds_read_b64_tr_b16 v[44:45], v22 offset:60416
    ds_read_b64_tr_b16 v[46:47], v22 offset:60672
    s_waitcnt lgkmcnt(10)
    v_mfma_f32_32x32x16_bf16 v[64:79], v[56:59], v[236:239], v[64:79]
    v_lshl_add_u32 v9, v9, 4, s36
    ds_write_b32 v8, v28
    v_mul_f32 v29, 0x3eb8aa3b, v28
    ds_read_b128 v[112:115], v9 offset:0
    ds_read_b128 v[116:119], v9 offset:32
    ds_read_b64_tr_b16 v[48:49], v22 offset:61440
    ds_read_b64_tr_b16 v[50:51], v22 offset:61696
    s_waitcnt lgkmcnt(13)
    v_mfma_f32_32x32x16_bf16 v[80:95], v[236:239], v[60:63], v[80:95]
    ds_read_b128 v[120:123], v9 offset:64
    ds_read_b128 v[124:127], v9 offset:96
    ds_read_b64_tr_b16 v[52:53], v22 offset:62464
    ds_read_b64_tr_b16 v[54:55], v22 offset:62720
    s_waitcnt lgkmcnt(15)
    v_mfma_f32_32x32x16_bf16 v[64:79], v[32:35], v[240:243], v[64:79]
    ds_read_b64_tr_b16 v[56:57], v22 offset:63488
    ds_read_b64_tr_b16 v[58:59], v22 offset:63744
    s_waitcnt lgkmcnt(15)
    v_mfma_f32_32x32x16_bf16 v[80:95], v[240:243], v[36:39], v[80:95]
    ds_read_b64_tr_b16 v[60:61], v22 offset:64512
    ds_read_b64_tr_b16 v[62:63], v22 offset:64768
    s_waitcnt lgkmcnt(15)
    v_mfma_f32_32x32x16_bf16 v[64:79], v[40:43], v[244:247], v[64:79]
    s_barrier
    ds_read_b64_tr_b16 v[32:33], v23 offset:0
    ds_read_b64_tr_b16 v[34:35], v23 offset:256
    s_waitcnt lgkmcnt(15)
    v_mfma_f32_32x32x16_bf16 v[80:95], v[244:247], v[44:47], v[80:95]
    ds_read_b64_tr_b16 v[36:37], v23 offset:1024
    ds_read_b64_tr_b16 v[38:39], v23 offset:1280
    s_waitcnt lgkmcnt(12)
    v_mfma_f32_32x32x16_bf16 v[64:79], v[48:51], v[248:251], v[64:79]
    ds_read_b64_tr_b16 v[40:41], v23 offset:2048
    ds_read_b64_tr_b16 v[42:43], v23 offset:2304
    s_waitcnt lgkmcnt(10)
    v_mfma_f32_32x32x16_bf16 v[80:95], v[248:251], v[52:55], v[80:95]
    ds_read_b64_tr_b16 v[44:45], v23 offset:3072
    ds_read_b64_tr_b16 v[46:47], v23 offset:3328
    s_waitcnt lgkmcnt(10)
    v_mfma_f32_32x32x16_bf16 v[64:79], v[56:59], v[252:255], v[64:79]
    ds_read_b64_tr_b16 v[48:49], v23 offset:4096
    ds_read_b64_tr_b16 v[50:51], v23 offset:4352
    s_waitcnt lgkmcnt(10)
    v_mfma_f32_32x32x16_bf16 v[80:95], v[252:255], v[60:63], v[80:95]
    ds_read_b64_tr_b16 v[52:53], v23 offset:5120
    ds_read_b64_tr_b16 v[54:55], v23 offset:5376
    s_waitcnt lgkmcnt(10)
    v_mfma_f32_32x32x16_bf16 v[96:111], v[32:35], v[128:131], 0
    ds_read_b64_tr_b16 v[56:57], v23 offset:6144
    ds_read_b64_tr_b16 v[58:59], v23 offset:6400
    s_waitcnt lgkmcnt(10)
    v_mfma_f32_32x32x16_bf16 v[96:111], v[36:39], v[132:135], v[96:111]
    ds_read_b64_tr_b16 v[60:61], v23 offset:7168
    ds_read_b64_tr_b16 v[62:63], v23 offset:7424
    s_waitcnt lgkmcnt(10)
    v_mfma_f32_32x32x16_bf16 v[96:111], v[40:43], v[136:139], v[96:111]
    ds_read_b128 v[32:35], v17 offset:1024
    s_waitcnt lgkmcnt(9)
    v_mfma_f32_32x32x16_bf16 v[96:111], v[44:47], v[140:143], v[96:111]
    ds_read_b128 v[36:39], v17 offset:2048
    s_waitcnt lgkmcnt(8)
    v_mfma_f32_32x32x16_bf16 v[96:111], v[48:51], v[144:147], v[96:111]
    ds_read_b64_tr_b16 v[40:41], v23 offset:8192
    ds_read_b64_tr_b16 v[42:43], v23 offset:8448
    s_waitcnt lgkmcnt(8)
    v_mfma_f32_32x32x16_bf16 v[96:111], v[52:55], v[148:151], v[96:111]
    ds_read_b64_tr_b16 v[44:45], v23 offset:9216
    ds_read_b64_tr_b16 v[46:47], v23 offset:9472
    s_waitcnt lgkmcnt(8)
    v_mfma_f32_32x32x16_bf16 v[96:111], v[56:59], v[152:155], v[96:111]
    ds_read_b64_tr_b16 v[48:49], v23 offset:10240
    ds_read_b64_tr_b16 v[50:51], v23 offset:10496
    s_waitcnt lgkmcnt(8)
    v_mfma_f32_32x32x16_bf16 v[96:111], v[60:63], v[156:159], v[96:111]
    ds_read_b64_tr_b16 v[52:53], v23 offset:11264
    ds_read_b64_tr_b16 v[54:55], v23 offset:11520
    s_waitcnt lgkmcnt(9)
    v_mfma_f32_32x32x16_bf16 v[64:79], v[32:35], v[24:27], v[64:79]
    ds_read_b64_tr_b16 v[56:57], v23 offset:12288
    ds_read_b64_tr_b16 v[58:59], v23 offset:12544
    s_waitcnt lgkmcnt(10)
    v_mfma_f32_32x32x16_bf16 v[80:95], v[24:27], v[36:39], v[80:95]
    ds_read_b64_tr_b16 v[60:61], v23 offset:13312
    ds_read_b64_tr_b16 v[62:63], v23 offset:13568
    s_waitcnt lgkmcnt(10)
    v_mfma_f32_32x32x16_bf16 v[96:111], v[40:43], v[160:163], v[96:111]
    ds_read_b64_tr_b16 v[32:33], v23 offset:14336
    ds_read_b64_tr_b16 v[34:35], v23 offset:14592
    s_waitcnt lgkmcnt(10)
    v_mfma_f32_32x32x16_bf16 v[96:111], v[44:47], v[164:167], v[96:111]
    v_mul_f32 v64, v28, v64
    v_mul_f32 v65, v28, v65
    v_mul_f32 v66, v28, v66
    v_mul_f32 v67, v28, v67
    v_mul_f32 v68, v28, v68
    ds_read_b64_tr_b16 v[36:37], v23 offset:15360
    ds_read_b64_tr_b16 v[38:39], v23 offset:15616
    s_waitcnt lgkmcnt(10)
    v_mfma_f32_32x32x16_bf16 v[96:111], v[48:51], v[168:171], v[96:111]
    v_mul_f32 v69, v28, v69
    v_mul_f32 v70, v28, v70
    v_mul_f32 v71, v28, v71
    v_cvt_pk_bf16_f32 v64, v64, v65
    v_cvt_pk_bf16_f32 v65, v66, v67
    ds_read_b64_tr_b16 v[40:41], v23 offset:16384
    ds_read_b64_tr_b16 v[42:43], v23 offset:16640
    s_waitcnt lgkmcnt(10)
    v_mfma_f32_32x32x16_bf16 v[96:111], v[52:55], v[172:175], v[96:111]
    v_cvt_pk_bf16_f32 v66, v68, v69
    v_cvt_pk_bf16_f32 v67, v70, v71
    ds_write_b128 v31, v[64:67] offset:0
    buffer_store_dwordx4 v[64:67], v1, s[56:59], s40 offen offset:0 sc1
    v_mul_f32 v72, v28, v72
    ds_read_b64_tr_b16 v[44:45], v23 offset:17408
    ds_read_b64_tr_b16 v[46:47], v23 offset:17664
    s_waitcnt lgkmcnt(11)
    v_mfma_f32_32x32x16_bf16 v[96:111], v[56:59], v[176:179], v[96:111]
    v_mul_f32 v73, v28, v73
    v_mul_f32 v74, v28, v74
    v_mul_f32 v75, v28, v75
    v_mul_f32 v76, v28, v76
    v_mul_f32 v77, v28, v77
    ds_read_b64_tr_b16 v[48:49], v23 offset:18432
    ds_read_b64_tr_b16 v[50:51], v23 offset:18688
    s_waitcnt lgkmcnt(11)
    v_mfma_f32_32x32x16_bf16 v[96:111], v[60:63], v[180:183], v[96:111]
    v_mul_f32 v78, v28, v78
    v_mul_f32 v79, v28, v79
    v_cvt_pk_bf16_f32 v72, v72, v73
    v_cvt_pk_bf16_f32 v73, v74, v75
    v_cvt_pk_bf16_f32 v74, v76, v77
    ds_read_b64_tr_b16 v[52:53], v23 offset:19456
    ds_read_b64_tr_b16 v[54:55], v23 offset:19712
    s_waitcnt lgkmcnt(11)
    v_mfma_f32_32x32x16_bf16 v[96:111], v[32:35], v[184:187], v[96:111]
    v_cvt_pk_bf16_f32 v75, v78, v79
    ds_write_b128 v31, v[72:75] offset:1024
    buffer_store_dwordx4 v[72:75], v1, s[56:59], s40 offen offset:1024 sc1
    s_waitcnt lgkmcnt(15)
    v_mul_f32 v80, v112, v80
    v_mul_f32 v81, v113, v81
    ds_read_b64_tr_b16 v[56:57], v23 offset:20480
    ds_read_b64_tr_b16 v[58:59], v23 offset:20736
    s_waitcnt lgkmcnt(12)
    v_mfma_f32_32x32x16_bf16 v[96:111], v[36:39], v[188:191], v[96:111]
    v_mul_f32 v82, v114, v82
    v_mul_f32 v83, v115, v83
    v_mul_f32 v84, v116, v84
    v_mul_f32 v85, v117, v85
    v_mul_f32 v86, v118, v86
    ds_read_b64_tr_b16 v[60:61], v23 offset:21504
    ds_read_b64_tr_b16 v[62:63], v23 offset:21760
    s_waitcnt lgkmcnt(12)
    v_mfma_f32_32x32x16_bf16 v[96:111], v[40:43], v[192:195], v[96:111]
    v_mul_f32 v87, v119, v87
    v_cvt_pk_bf16_f32 v80, v80, v81
    v_cvt_pk_bf16_f32 v81, v82, v83
    v_cvt_pk_bf16_f32 v82, v84, v85
    v_cvt_pk_bf16_f32 v83, v86, v87
    ds_read_b64_tr_b16 v[32:33], v23 offset:22528
    ds_read_b64_tr_b16 v[34:35], v23 offset:22784
    s_waitcnt lgkmcnt(11)
    v_mfma_f32_32x32x16_bf16 v[96:111], v[44:47], v[196:199], v[96:111]
    ds_write_b128 v31, v[80:83] offset:2048
    buffer_store_dwordx4 v[80:83], v30, s[56:59], s42 offen offset:0 sc1
    v_mul_f32 v88, v120, v88
    v_mul_f32 v89, v121, v89
    v_mul_f32 v90, v122, v90
    ds_read_b64_tr_b16 v[36:37], v23 offset:23552
    ds_read_b64_tr_b16 v[38:39], v23 offset:23808
    s_waitcnt lgkmcnt(12)
    v_mfma_f32_32x32x16_bf16 v[96:111], v[48:51], v[200:203], v[96:111]
    v_mul_f32 v91, v123, v91
    v_mul_f32 v92, v124, v92
    v_mul_f32 v93, v125, v93
    v_mul_f32 v94, v126, v94
    v_mul_f32 v95, v127, v95
    ds_read_b64_tr_b16 v[40:41], v23 offset:24576
    ds_read_b64_tr_b16 v[42:43], v23 offset:24832
    s_waitcnt lgkmcnt(12)
    v_mfma_f32_32x32x16_bf16 v[96:111], v[52:55], v[204:207], v[96:111]
    v_cvt_pk_bf16_f32 v88, v88, v89
    v_cvt_pk_bf16_f32 v89, v90, v91
    v_cvt_pk_bf16_f32 v90, v92, v93
    v_cvt_pk_bf16_f32 v91, v94, v95
    ds_write_b128 v31, v[88:91] offset:3072
    ds_read_b64_tr_b16 v[44:45], v23 offset:25600
    ds_read_b64_tr_b16 v[46:47], v23 offset:25856
    s_waitcnt lgkmcnt(12)
    v_mfma_f32_32x32x16_bf16 v[96:111], v[56:59], v[208:211], v[96:111]
    buffer_store_dwordx4 v[88:91], v30, s[56:59], s42 offen offset:512 sc1
    s_nop 0
    ds_read_b64_tr_b16 v[48:49], v23 offset:26624
    ds_read_b64_tr_b16 v[50:51], v23 offset:26880
    s_waitcnt lgkmcnt(12)
    v_mfma_f32_32x32x16_bf16 v[96:111], v[60:63], v[212:215], v[96:111]
    s_nop 0
    ds_read_b64_tr_b16 v[52:53], v23 offset:27648
    ds_read_b64_tr_b16 v[54:55], v23 offset:27904
    s_waitcnt lgkmcnt(12)
    v_mfma_f32_32x32x16_bf16 v[96:111], v[32:35], v[216:219], v[96:111]
    s_waitcnt lgkmcnt(6)
    s_barrier
    ds_read_b64_tr_b16 v[56:57], v23 offset:28672
    ds_read_b64_tr_b16 v[58:59], v23 offset:28928
    s_waitcnt lgkmcnt(11)
    v_mfma_f32_32x32x16_bf16 v[96:111], v[36:39], v[220:223], v[96:111]
    ds_read_b64_tr_b16 v[60:61], v23 offset:29696
    ds_read_b64_tr_b16 v[62:63], v23 offset:29952
    s_waitcnt lgkmcnt(11)
    v_mfma_f32_32x32x16_bf16 v[96:111], v[40:43], v[224:227], v[96:111]
    ds_read_b64_tr_b16 v[32:33], v23 offset:30720
    ds_read_b64_tr_b16 v[34:35], v23 offset:30976
    s_waitcnt lgkmcnt(10)
    v_mfma_f32_32x32x16_bf16 v[96:111], v[44:47], v[228:231], v[96:111]
    ds_read_b64_tr_b16 v[36:37], v23 offset:31744
    ds_read_b64_tr_b16 v[38:39], v23 offset:32000
    s_waitcnt lgkmcnt(10)
    v_mfma_f32_32x32x16_bf16 v[96:111], v[48:51], v[232:235], v[96:111]
    ds_read_b128 v[40:43], v17 offset:0
    s_waitcnt lgkmcnt(9)
    v_mfma_f32_32x32x16_bf16 v[96:111], v[52:55], v[236:239], v[96:111]
    s_waitcnt lgkmcnt(7)
    v_mfma_f32_32x32x16_bf16 v[96:111], v[56:59], v[240:243], v[96:111]
    s_waitcnt lgkmcnt(5)
    v_mfma_f32_32x32x16_bf16 v[96:111], v[60:63], v[244:247], v[96:111]
    s_waitcnt lgkmcnt(3)
    v_mfma_f32_32x32x16_bf16 v[96:111], v[32:35], v[248:251], v[96:111]
    s_waitcnt lgkmcnt(1)
    v_mfma_f32_32x32x16_bf16 v[96:111], v[36:39], v[252:255], v[96:111]
    s_waitcnt lgkmcnt(0)
    v_mfma_f32_32x32x16_bf16 v[96:111], v[40:43], v[24:27], v[96:111]
    s_nop 7
    s_nop 3
    v_mul_f32 v96, v29, v96
    v_mul_f32 v97, v29, v97
    v_mul_f32 v98, v29, v98
    v_mul_f32 v99, v29, v99
    v_mul_f32 v100, v29, v100
    v_mul_f32 v101, v29, v101
    v_mul_f32 v102, v29, v102
    v_mul_f32 v103, v29, v103
    v_cvt_pk_bf16_f32 v96, v96, v97
    v_cvt_pk_bf16_f32 v97, v98, v99
    v_cvt_pk_bf16_f32 v98, v100, v101
    v_cvt_pk_bf16_f32 v99, v102, v103
    buffer_store_dwordx4 v[96:99], v1, s[56:59], s44 offen offset:0 sc1
    v_mul_f32 v104, v29, v104
    v_mul_f32 v105, v29, v105
    v_mul_f32 v106, v29, v106
    v_mul_f32 v107, v29, v107
    v_mul_f32 v108, v29, v108
    v_mul_f32 v109, v29, v109
    v_mul_f32 v110, v29, v110
    v_mul_f32 v111, v29, v111
    v_cvt_pk_bf16_f32 v104, v104, v105
    v_cvt_pk_bf16_f32 v105, v106, v107
    v_cvt_pk_bf16_f32 v106, v108, v109
    v_cvt_pk_bf16_f32 v107, v110, v111
    buffer_store_dwordx4 v[104:107], v1, s[56:59], s44 offen offset:1024 sc1
    v_mov_b32 v8, 1
    s_mov_b64 exec, 1
    s_cmp_lg_u32 s15, 0
    s_waitcnt vmcnt(0)
    s_cbranch_scc1 mega_kernel_sig10a
    buffer_store_dword v8, off, s[8:11], s43
mega_kernel_sig10b:
    s_mov_b64 exec, -1
    s_branch mega_kernel_att
mega_kernel_qkv_h:
    s_barrier
    v_and_b32 v8, 11, v0
    v_cmp_eq_u32 vcc, 0, v8
    s_nop 1
    v_cndmask_b32 v8, 0, v6, vcc
    v_mov_b32 v9, v8
    v_mov_b32 v10, v8
    v_mov_b32 v11, v8
    s_lshl_b32 s36, s16, 10
    s_add_u32 s36, s36, 159744
    v_add_u32 v12, s36, v1
    ds_write_b128 v12, v[8:11]
    s_lshl_b32 s36, s16, 12
    s_add_u32 s36, s36, 114688
    v_add_u32 v12, s36, v1
    s_lshl_b32 s40, s19, 18
    s_lshr_b32 s41, s18, 2
    s_lshl_b32 s41, s41, 13
    s_add_u32 s40, s40, s41
    s_lshl_b32 s41, s16, 10
    s_add_u32 s40, s40, s41
    s_add_u32 s40, s40, 0x10000
    s_add_u32 s41, s40, 0x20000
    s_add_u32 s42, s40, 4096
    v_and_b32 v30, 0x1ff, v2
    v_bfe_u32 v31, v0, 4, 1
    v_lshl_add_u32 v30, v31, 17, v30
    s_lshl_b32 s43, s19, 2
    s_add_u32 s43, s43, s16
    s_lshl_b32 s43, s43, 7
    s_lshr_b32 s36, s18, 2
    s_lshl_b32 s36, s36, 2
    s_add_u32 s43, s43, s36
    s_add_u32 s43, s43, 0x6000
    s_barrier
    ds_read_b128 v[32:35], v12 offset:0
    ds_read_b128 v[36:39], v12 offset:1024
    ds_read_b128 v[40:43], v12 offset:2048
    ds_read_b128 v[44:47], v12 offset:3072
    s_waitcnt lgkmcnt(3)
    buffer_store_dwordx4 v[32:35], v1, s[8:11], s40 offen sc1
    s_waitcnt lgkmcnt(2)
    buffer_store_dwordx4 v[36:39], v1, s[8:11], s41 offen sc1
    s_waitcnt lgkmcnt(1)
    buffer_store_dwordx4 v[40:43], v30, s[8:11], s42 offen offset:0 sc1
    s_waitcnt lgkmcnt(0)
    buffer_store_dwordx4 v[44:47], v30, s[8:11], s42 offen offset:512 sc1
    v_mov_b32 v8, 1
    s_mov_b64 exec, 1
    s_waitcnt vmcnt(0)
    buffer_store_dword v8, off, s[8:11], s43 sc1
    s_mov_b64 exec, -1
    s_branch mega_kernel_att
mega_kernel_qkv_c:
    s_mul_i32 s44, s18, 114688
    s_lshl_b32 s45, s19, 11
    s_add_u32 s44, s44, s45
    s_add_u32 s44, s44, 0x240000
    s_add_u32 s40, s44, 0x8000
    s_add_u32 s42, s44, 0x10000
    v_and_b32 v30, 0x1ff, v2
    v_bfe_u32 v31, v0, 4, 1
    v_lshl_add_u32 v30, v31, 10, v30
    s_lshl_b32 s43, s12, 4
    s_add_u32 s43, s43, s19
    s_lshl_b32 s43, s43, 7
    s_and_b32 s36, s18, 7
    s_lshl_b32 s36, s36, 2
    s_add_u32 s43, s43, s36
    s_add_u32 s43, s43, 0x2000
    s_lshl_b32 s36, s16, 12
    s_add_u32 s36, s36, 114688
    v_add_u32 v31, s36, v1
    s_lshl_b32 s39, s16, 7
    s_add_u32 s39, s39, 112640
    s_lshl_b32 s36, s18, 7
    s_add_u32 s36, s36, 0x0
    v_and_b32 v8, 15, v0
    v_lshlrev_b32 v8, 2, v8
    s_lshl_b32 s37, s18, 12
    s_add_u32 s37, s37, 0x200000
    s_lshl_b32 s38, s18, 15
    s_add_u32 s38, s38, 0x0
    s_mov_b32 s35, 0
mega_kernel_poll12:
    buffer_load_dword v9, v8, s[8:11], s36 offen sc1
    s_add_u32 s35, s35, 1
    s_cmp_gt_u32 s35, 20000
    s_cbranch_scc1 mega_kernel_end
    s_waitcnt vmcnt(0)
    v_cmp_ne_u32 vcc, 1, v9
    s_cbranch_vccnz mega_kernel_poll12
mega_kernel_poll12x:
    s_cmp_lg_u32 s15, 0
    s_cbranch_scc1 mega_kernel_poll12a
mega_kernel_poll12b:
    buffer_load_dwordx4 v[128:131], v1, s[56:59], s38 offen offset:0 sc1
    buffer_load_dwordx4 v[132:135], v1, s[56:59], s38 offen offset:1024 sc1
    buffer_load_dwordx4 v[136:139], v1, s[56:59], s38 offen offset:2048 sc1
    buffer_load_dwordx4 v[140:143], v1, s[56:59], s38 offen offset:3072 sc1
    s_add_u32 s38, s38, 4096
    buffer_load_dwordx4 v[144:147], v1, s[56:59], s38 offen offset:0 sc1
    buffer_load_dwordx4 v[148:151], v1, s[56:59], s38 offen offset:1024 sc1
    buffer_load_dwordx4 v[8:11], v4, s[56:59], s37 offen offset:0 sc1
    buffer_load_dwordx4 v[12:15], v4, s[56:59], s37 offen offset:512 sc1
    buffer_load_dwordx4 v[16:19], v4, s[56:59], s37 offen offset:1024 sc1
    buffer_load_dwordx4 v[20:23], v4, s[56:59], s37 offen offset:1536 sc1
    buffer_load_dwordx4 v[152:155], v1, s[56:59], s38 offen offset:2048 sc1
    buffer_load_dwordx4 v[156:159], v1, s[56:59], s38 offen offset:3072 sc1
    s_add_u32 s38, s38, 4096
    buffer_load_dwordx4 v[160:163], v1, s[56:59], s38 offen offset:0 sc1
    buffer_load_dwordx4 v[164:167], v1, s[56:59], s38 offen offset:1024 sc1
    buffer_load_dwordx4 v[168:171], v1, s[56:59], s38 offen offset:2048 sc1
    buffer_load_dwordx4 v[172:175], v1, s[56:59], s38 offen offset:3072 sc1
    s_add_u32 s38, s38, 4096
    s_barrier
    ds_read_b128 v[32:35], v2 offset:1024
    ds_read_b128 v[36:39], v2 offset:2048
    ds_read_b128 v[40:43], v2 offset:0
    ds_read_b128 v[44:47], v2 offset:4096
    ds_read_b128 v[48:51], v2 offset:5120
    ds_read_b128 v[52:55], v2 offset:3072
    ds_read_b128 v[56:59], v2 offset:7168
    s_waitcnt vmcnt(15) lgkmcnt(6)
    v_mfma_f32_32x32x16_bf16 v[64:79], v[32:35], v[128:131], 0
    buffer_load_dwordx4 v[176:179], v1, s[56:59], s38 offen offset:0 sc1
    ds_read_b128 v[60:63], v2 offset:8192
    s_waitcnt lgkmcnt(6)
    v_mfma_f32_32x32x16_bf16 v[80:95], v[128:131], v[36:39], 0
    ds_read_b128 v[32:35], v2 offset:6144
    s_waitcnt lgkmcnt(6)
    v_mfma_f32_32x32x16_bf16 v[96:111], v[40:43], v[128:131], 0
    ds_read_b128 v[36:39], v2 offset:10240
    s_waitcnt vmcnt(15) lgkmcnt(6)
    v_mfma_f32_32x32x16_bf16 v[64:79], v[44:47], v[132:135], v[64:79]
    buffer_load_dwordx4 v[180:183], v1, s[56:59], s38 offen offset:1024 sc1
    ds_read_b128 v[40:43], v2 offset:11264
    s_waitcnt lgkmcnt(6)
    v_mfma_f32_32x32x16_bf16 v[80:95], v[132:135], v[48:51], v[80:95]
    ds_read_b128 v[44:47], v2 offset:9216
    s_waitcnt lgkmcnt(6)
    v_mfma_f32_32x32x16_bf16 v[96:111], v[52:55], v[132:135], v[96:111]
    ds_read_b128 v[48:51], v2 offset:13312
    s_waitcnt vmcnt(15) lgkmcnt(6)
    v_mfma_f32_32x32x16_bf16 v[64:79], v[56:59], v[136:139], v[64:79]
    buffer_load_dwordx4 v[184:187], v1, s[56:59], s38 offen offset:2048 sc1
    ds_read_b128 v[52:55], v2 offset:14336
    s_waitcnt lgkmcnt(6)
    v_mfma_f32_32x32x16_bf16 v[80:95], v[136:139], v[60:63], v[80:95]
    ds_read_b128 v[56:59], v2 offset:12288
    s_waitcnt lgkmcnt(6)
    v_mfma_f32_32x32x16_bf16 v[96:111], v[32:35], v[136:139], v[96:111]
    ds_read_b128 v[60:63], v2 offset:16384
    s_waitcnt vmcnt(15) lgkmcnt(6)
    v_mfma_f32_32x32x16_bf16 v[64:79], v[36:39], v[140:143], v[64:79]
    buffer_load_dwordx4 v[188:191], v1, s[56:59], s38 offen offset:3072 sc1
    s_add_u32 s38, s38, 4096
    ds_read_b128 v[32:35], v2 offset:17408
    s_waitcnt lgkmcnt(6)
    v_mfma_f32_32x32x16_bf16 v[80:95], v[140:143], v[40:43], v[80:95]
    ds_read_b128 v[36:39], v2 offset:15360
    s_waitcnt lgkmcnt(6)
    v_mfma_f32_32x32x16_bf16 v[96:111], v[44:47], v[140:143], v[96:111]
    ds_read_b128 v[40:43], v2 offset:19456
    s_waitcnt vmcnt(15) lgkmcnt(6)
    v_mfma_f32_32x32x16_bf16 v[64:79], v[48:51], v[144:147], v[64:79]
    buffer_load_dwordx4 v[192:195], v1, s[56:59], s38 offen offset:0 sc1
    ds_read_b128 v[44:47], v2 offset:20480
    s_waitcnt lgkmcnt(6)
    v_mfma_f32_32x32x16_bf16 v[80:95], v[144:147], v[52:55], v[80:95]
    ds_read_b128 v[48:51], v2 offset:18432
    s_waitcnt lgkmcnt(6)
    v_mfma_f32_32x32x16_bf16 v[96:111], v[56:59], v[144:147], v[96:111]
    ds_read_b128 v[52:55], v2 offset:22528
    s_waitcnt vmcnt(15) lgkmcnt(6)
    v_mfma_f32_32x32x16_bf16 v[64:79], v[60:63], v[148:151], v[64:79]
    buffer_load_dwordx4 v[196:199], v1, s[56:59], s38 offen offset:1024 sc1
    ds_read_b128 v[56:59], v2 offset:23552
    s_waitcnt lgkmcnt(6)
    v_mfma_f32_32x32x16_bf16 v[80:95], v[148:151], v[32:35], v[80:95]
    ds_read_b128 v[60:63], v2 offset:21504
    s_waitcnt lgkmcnt(6)
    v_mfma_f32_32x32x16_bf16 v[96:111], v[36:39], v[148:151], v[96:111]
    ds_read_b128 v[32:35], v2 offset:25600
    s_waitcnt vmcnt(11) lgkmcnt(6)
    v_mfma_f32_32x32x16_bf16 v[64:79], v[40:43], v[152:155], v[64:79]
    buffer_load_dwordx4 v[200:203], v1, s[56:59], s38 offen offset:2048 sc1
    ds_read_b128 v[36:39], v2 offset:26624
    s_waitcnt lgkmcnt(6)
    v_mfma_f32_32x32x16_bf16 v[80:95], v[152:155], v[44:47], v[80:95]
    ds_read_b128 v[40:43], v2 offset:24576
    s_waitcnt lgkmcnt(6)
    v_mfma_f32_32x32x16_bf16 v[96:111], v[48:51], v[152:155], v[96:111]
    ds_read_b128 v[44:47], v2 offset:28672
    s_waitcnt vmcnt(11) lgkmcnt(6)
    v_mfma_f32_32x32x16_bf16 v[64:79], v[52:55], v[156:159], v[64:79]
    buffer_load_dwordx4 v[204:207], v1, s[56:59], s38 offen offset:3072 sc1
    s_add_u32 s38, s38, 4096
    s_waitcnt vmcnt(14)
    v_add_f32 v8, v8, v10
    v_add_f32 v12, v12, v14
    v_add_f32 v16, v16, v18
    v_add_f32 v20, v20, v22
    v_add_f32 v9, v9, v11
    v_add_f32 v13, v13, v15
    ds_read_b128 v[48:51], v2 offset:29696
    s_waitcnt lgkmcnt(6)
    v_mfma_f32_32x32x16_bf16 v[80:95], v[156:159], v[56:59], v[80:95]
    v_add_f32 v17, v17, v19
    v_add_f32 v21, v21, v23
    v_add_f32 v8, v8, v12
    v_add_f32 v16, v16, v20
    v_add_f32 v9, v9, v13
    v_add_f32 v17, v17, v21
    ds_read_b128 v[52:55], v2 offset:27648
    s_waitcnt lgkmcnt(6)
    v_mfma_f32_32x32x16_bf16 v[96:111], v[60:63], v[156:159], v[96:111]
    v_add_f32 v8, v8, v16
    v_add_f32 v9, v9, v17
    v_mov_b32 v10, v8
    v_mov_b32 v11, v9
    s_nop 0
    v_permlane32_swap_b32 v8, v10
    v_permlane32_swap_b32 v9, v11
    ds_read_b128 v[56:59], v2 offset:31744
    s_waitcnt vmcnt(11) lgkmcnt(6)
    v_mfma_f32_32x32x16_bf16 v[64:79], v[32:35], v[160:163], v[64:79]
    buffer_load_dwordx4 v[208:211], v1, s[56:59], s38 offen offset:0 sc1
    v_add_f32 v8, v8, v10
    v_add_f32 v9, v9, v11
    v_mul_f32 v8, 0xbb000000, v8
    v_mul_f32 v9, 0x3b000000, v9
    v_fma_f32 v9, -v8, v8, v9
    v_max_f32 v9, 0, v9
    ds_read_b128 v[60:63], v2 offset:32768
    s_waitcnt lgkmcnt(6)
    v_mfma_f32_32x32x16_bf16 v[80:95], v[160:163], v[36:39], v[80:95]
    v_add_f32 v9, 0x3727c5ac, v9
    v_rsq_f32 v28, v9
    v_cvt_pk_bf16_f32 v25, v8, 0
    v_lshlrev_b32 v13, 16, v25
    v_sub_f32 v13, v8, v13
    v_cvt_pk_bf16_f32 v24, v8, v13
    ds_read_b128 v[32:35], v2 offset:30720
    s_waitcnt lgkmcnt(6)
    v_mfma_f32_32x32x16_bf16 v[96:111], v[40:43], v[160:163], v[96:111]
    v_cvt_pk_bf16_f32 v26, v8, v13
    v_mov_b32 v27, v25
    v_and_b32 v8, 31, v0
    v_lshl_add_u32 v8, v8, 2, s39
    v_lshrrev_b32 v9, 5, v0
    v_lshl_add_u32 v9, v9, 4, s39
    ds_read_b128 v[36:39], v2 offset:34816
    s_waitcnt vmcnt(11) lgkmcnt(6)
    v_mfma_f32_32x32x16_bf16 v[64:79], v[44:47], v[164:167], v[64:79]
    buffer_load_dwordx4 v[212:215], v1, s[56:59], s38 offen offset:1024 sc1
    ds_write_b32 v8, v28
    v_mul_f32 v29, 0x3eb8aa3b, v28
    ds_read_b128 v[112:115], v9 offset:0
    ds_read_b128 v[116:119], v9 offset:32
    ds_read_b128 v[120:123], v9 offset:64
    ds_read_b128 v[124:127], v9 offset:96
    ds_read_b128 v[40:43], v2 offset:35840
    s_waitcnt lgkmcnt(11)
    v_mfma_f32_32x32x16_bf16 v[80:95], v[164:167], v[48:51], v[80:95]
    ds_read_b128 v[44:47], v2 offset:33792
    s_waitcnt lgkmcnt(11)
    v_mfma_f32_32x32x16_bf16 v[96:111], v[52:55], v[164:167], v[96:111]
    ds_read_b128 v[48:51], v2 offset:37888
    s_waitcnt vmcnt(11) lgkmcnt(11)
    v_mfma_f32_32x32x16_bf16 v[64:79], v[56:59], v[168:171], v[64:79]
    buffer_load_dwordx4 v[216:219], v1, s[56:59], s38 offen offset:2048 sc1
    ds_read_b128 v[52:55], v2 offset:38912
    s_waitcnt lgkmcnt(11)
    v_mfma_f32_32x32x16_bf16 v[80:95], v[168:171], v[60:63], v[80:95]
    ds_read_b128 v[56:59], v2 offset:36864
    s_waitcnt lgkmcnt(11)
    v_mfma_f32_32x32x16_bf16 v[96:111], v[32:35], v[168:171], v[96:111]
    ds_read_b128 v[60:63], v2 offset:40960
    s_waitcnt vmcnt(11) lgkmcnt(11)
    v_mfma_f32_32x32x16_bf16 v[64:79], v[36:39], v[172:175], v[64:79]
    buffer_load_dwordx4 v[220:223], v1, s[56:59], s38 offen offset:3072 sc1
    s_add_u32 s38, s38, 4096
    ds_read_b128 v[32:35], v2 offset:41984
    s_waitcnt lgkmcnt(6)
    v_mfma_f32_32x32x16_bf16 v[80:95], v[172:175], v[40:43], v[80:95]
    ds_read_b128 v[36:39], v2 offset:39936
    s_waitcnt lgkmcnt(6)
    v_mfma_f32_32x32x16_bf16 v[96:111], v[44:47], v[172:175], v[96:111]
    ds_read_b128 v[40:43], v2 offset:44032
    s_waitcnt vmcnt(11) lgkmcnt(6)
    v_mfma_f32_32x32x16_bf16 v[64:79], v[48:51], v[176:179], v[64:79]
    buffer_load_dwordx4 v[224:227], v1, s[56:59], s38 offen offset:0 sc1
    ds_read_b128 v[44:47], v2 offset:45056
    s_waitcnt lgkmcnt(6)
    v_mfma_f32_32x32x16_bf16 v[80:95], v[176:179], v[52:55], v[80:95]
    ds_read_b128 v[48:51], v2 offset:43008
    s_waitcnt lgkmcnt(6)
    v_mfma_f32_32x32x16_bf16 v[96:111], v[56:59], v[176:179], v[96:111]
    ds_read_b128 v[52:55], v2 offset:47104
    s_waitcnt vmcnt(11) lgkmcnt(6)
    v_mfma_f32_32x32x16_bf16 v[64:79], v[60:63], v[180:183], v[64:79]
    buffer_load_dwordx4 v[228:231], v1, s[56:59], s38 offen offset:1024 sc1
    ds_read_b128 v[56:59], v2 offset:48128
    s_waitcnt lgkmcnt(6)
    v_mfma_f32_32x32x16_bf16 v[80:95], v[180:183], v[32:35], v[80:95]
    ds_read_b128 v[60:63], v2 offset:46080
    s_waitcnt lgkmcnt(6)
    v_mfma_f32_32x32x16_bf16 v[96:111], v[36:39], v[180:183], v[96:111]
    ds_read_b128 v[32:35], v2 offset:50176
    s_waitcnt vmcnt(11) lgkmcnt(6)
    v_mfma_f32_32x32x16_bf16 v[64:79], v[40:43], v[184:187], v[64:79]
    buffer_load_dwordx4 v[232:235], v1, s[56:59], s38 offen offset:2048 sc1
    ds_read_b128 v[36:39], v2 offset:51200
    s_waitcnt lgkmcnt(6)
    v_mfma_f32_32x32x16_bf16 v[80:95], v[184:187], v[44:47], v[80:95]
    ds_read_b128 v[40:43], v2 offset:49152
    s_waitcnt lgkmcnt(6)
    v_mfma_f32_32x32x16_bf16 v[96:111], v[48:51], v[184:187], v[96:111]
    ds_read_b128 v[44:47], v2 offset:53248
    s_waitcnt vmcnt(11) lgkmcnt(6)
    v_mfma_f32_32x32x16_bf16 v[64:79], v[52:55], v[188:191], v[64:79]
    buffer_load_dwordx4 v[236:239], v1, s[56:59], s38 offen offset:3072 sc1
    s_add_u32 s38, s38, 4096
    ds_read_b128 v[48:51], v2 offset:54272
    s_waitcnt lgkmcnt(6)
    v_mfma_f32_32x32x16_bf16 v[80:95], v[188:191], v[56:59], v[80:95]
    ds_read_b128 v[52:55], v2 offset:52224
    s_waitcnt lgkmcnt(6)
    v_mfma_f32_32x32x16_bf16 v[96:111], v[60:63], v[188:191], v[96:111]
    ds_read_b128 v[56:59], v2 offset:56320
    s_waitcnt vmcnt(11) lgkmcnt(6)
    v_mfma_f32_32x32x16_bf16 v[64:79], v[32:35], v[192:195], v[64:79]
    buffer_load_dwordx4 v[240:243], v1, s[56:59], s38 offen offset:0 sc1
    ds_read_b128 v[60:63], v2 offset:57344
    s_waitcnt lgkmcnt(6)
    v_mfma_f32_32x32x16_bf16 v[80:95], v[192:195], v[36:39], v[80:95]
    ds_read_b128 v[32:35], v2 offset:55296
    s_waitcnt lgkmcnt(6)
    v_mfma_f32_32x32x16_bf16 v[96:111], v[40:43], v[192:195], v[96:111]
    ds_read_b128 v[36:39], v2 offset:59392
    s_waitcnt vmcnt(11) lgkmcnt(6)
    v_mfma_f32_32x32x16_bf16 v[64:79], v[44:47], v[196:199], v[64:79]
    buffer_load_dwordx4 v[244:247], v1, s[56:59], s38 offen offset:1024 sc1
    ds_read_b128 v[40:43], v2 offset:60416
    s_waitcnt lgkmcnt(6)
    v_mfma_f32_32x32x16_bf16 v[80:95], v[196:199], v[48:51], v[80:95]
    ds_read_b128 v[44:47], v2 offset:58368
    s_waitcnt lgkmcnt(6)
    v_mfma_f32_32x32x16_bf16 v[96:111], v[52:55], v[196:199], v[96:111]
    ds_read_b128 v[48:51], v2 offset:62464
    s_waitcnt vmcnt(11) lgkmcnt(6)
    v_mfma_f32_32x32x16_bf16 v[64:79], v[56:59], v[200:203], v[64:79]
    buffer_load_dwordx4 v[248:251], v1, s[56:59], s38 offen offset:2048 sc1
    ds_read_b128 v[52:55], v2 offset:63488
    s_waitcnt lgkmcnt(6)
    v_mfma_f32_32x32x16_bf16 v[80:95], v[200:203], v[60:63], v[80:95]
    ds_read_b128 v[56:59], v2 offset:61440
    s_waitcnt lgkmcnt(6)
    v_mfma_f32_32x32x16_bf16 v[96:111], v[32:35], v[200:203], v[96:111]
    ds_read_b128 v[60:63], v3 offset:0
    s_waitcnt vmcnt(11) lgkmcnt(6)
    v_mfma_f32_32x32x16_bf16 v[64:79], v[36:39], v[204:207], v[64:79]
    buffer_load_dwordx4 v[252:255], v1, s[56:59], s38 offen offset:3072 sc1
    s_add_u32 s38, s38, 4096
    ds_read_b128 v[32:35], v3 offset:1024
    s_waitcnt lgkmcnt(6)
    v_mfma_f32_32x32x16_bf16 v[80:95], v[204:207], v[40:43], v[80:95]
    ds_read_b128 v[36:39], v2 offset:64512
    s_waitcnt lgkmcnt(6)
    v_mfma_f32_32x32x16_bf16 v[96:111], v[44:47], v[204:207], v[96:111]
    ds_read_b128 v[40:43], v3 offset:3072
    s_waitcnt vmcnt(11) lgkmcnt(6)
    v_mfma_f32_32x32x16_bf16 v[64:79], v[48:51], v[208:211], v[64:79]
    ds_read_b128 v[44:47], v3 offset:4096
    s_waitcnt lgkmcnt(6)
    v_mfma_f32_32x32x16_bf16 v[80:95], v[208:211], v[52:55], v[80:95]
    ds_read_b128 v[48:51], v3 offset:2048
    s_waitcnt lgkmcnt(6)
    v_mfma_f32_32x32x16_bf16 v[96:111], v[56:59], v[208:211], v[96:111]
    ds_read_b128 v[52:55], v3 offset:6144
    s_waitcnt vmcnt(10) lgkmcnt(6)
    v_mfma_f32_32x32x16_bf16 v[64:79], v[60:63], v[212:215], v[64:79]
    ds_read_b128 v[56:59], v3 offset:7168
    s_waitcnt lgkmcnt(6)
    v_mfma_f32_32x32x16_bf16 v[80:95], v[212:215], v[32:35], v[80:95]
    ds_read_b128 v[60:63], v3 offset:5120
    s_waitcnt lgkmcnt(6)
    v_mfma_f32_32x32x16_bf16 v[96:111], v[36:39], v[212:215], v[96:111]
    ds_read_b128 v[32:35], v3 offset:9216
    s_waitcnt vmcnt(9) lgkmcnt(6)
    v_mfma_f32_32x32x16_bf16 v[64:79], v[40:43], v[216:219], v[64:79]
    ds_read_b128 v[36:39], v3 offset:10240
    s_waitcnt lgkmcnt(6)
    v_mfma_f32_32x32x16_bf16 v[80:95], v[216:219], v[44:47], v[80:95]
    ds_read_b128 v[40:43], v3 offset:8192
    s_waitcnt lgkmcnt(6)
    v_mfma_f32_32x32x16_bf16 v[96:111], v[48:51], v[216:219], v[96:111]
    ds_read_b128 v[44:47], v3 offset:12288
    s_waitcnt vmcnt(8) lgkmcnt(6)
    v_mfma_f32_32x32x16_bf16 v[64:79], v[52:55], v[220:223], v[64:79]
    ds_read_b128 v[48:51], v3 offset:13312
    s_waitcnt lgkmcnt(6)
    v_mfma_f32_32x32x16_bf16 v[80:95], v[220:223], v[56:59], v[80:95]
    ds_read_b128 v[52:55], v3 offset:15360
    s_waitcnt lgkmcnt(6)
    v_mfma_f32_32x32x16_bf16 v[96:111], v[60:63], v[220:223], v[96:111]
    ds_read_b128 v[56:59], v3 offset:16384
    s_waitcnt vmcnt(7) lgkmcnt(6)
    v_mfma_f32_32x32x16_bf16 v[64:79], v[32:35], v[224:227], v[64:79]
    ds_read_b128 v[60:63], v3 offset:18432
    s_waitcnt lgkmcnt(6)
    v_mfma_f32_32x32x16_bf16 v[80:95], v[224:227], v[36:39], v[80:95]
    ds_read_b128 v[32:35], v3 offset:19456
    s_waitcnt lgkmcnt(6)
    v_mfma_f32_32x32x16_bf16 v[96:111], v[40:43], v[224:227], v[96:111]
    ds_read_b128 v[36:39], v3 offset:21504
    s_waitcnt vmcnt(6) lgkmcnt(6)
    v_mfma_f32_32x32x16_bf16 v[64:79], v[44:47], v[228:231], v[64:79]
    ds_read_b128 v[40:43], v3 offset:22528
    s_waitcnt lgkmcnt(6)
    v_mfma_f32_32x32x16_bf16 v[80:95], v[228:231], v[48:51], v[80:95]
    ds_read_b128 v[44:47], v3 offset:24576
    s_waitcnt vmcnt(5) lgkmcnt(6)
    v_mfma_f32_32x32x16_bf16 v[64:79], v[52:55], v[232:235], v[64:79]
    ds_read_b128 v[48:51], v3 offset:25600
    s_waitcnt lgkmcnt(6)
    v_mfma_f32_32x32x16_bf16 v[80:95], v[232:235], v[56:59], v[80:95]
    ds_read_b128 v[52:55], v3 offset:27648
    s_waitcnt vmcnt(4) lgkmcnt(6)
    v_mfma_f32_32x32x16_bf16 v[64:79], v[60:63], v[236:239], v[64:79]
    ds_read_b128 v[56:59], v3 offset:28672
    s_waitcnt lgkmcnt(6)
    v_mfma_f32_32x32x16_bf16 v[80:95], v[236:239], v[32:35], v[80:95]
    ds_read_b128 v[60:63], v3 offset:30720
    s_waitcnt vmcnt(3) lgkmcnt(6)
    v_mfma_f32_32x32x16_bf16 v[64:79], v[36:39], v[240:243], v[64:79]
    ds_read_b128 v[32:35], v3 offset:31744
    s_waitcnt lgkmcnt(6)
    v_mfma_f32_32x32x16_bf16 v[80:95], v[240:243], v[40:43], v[80:95]
    ds_read_b128 v[36:39], v3 offset:33792
    s_waitcnt vmcnt(2) lgkmcnt(6)
    v_mfma_f32_32x32x16_bf16 v[64:79], v[44:47], v[244:247], v[64:79]
    ds_read_b128 v[40:43], v3 offset:34816
    s_waitcnt lgkmcnt(6)
    v_mfma_f32_32x32x16_bf16 v[80:95], v[244:247], v[48:51], v[80:95]
    ds_read_b128 v[44:47], v3 offset:11264
    s_waitcnt vmcnt(1) lgkmcnt(6)
    v_mfma_f32_32x32x16_bf16 v[64:79], v[52:55], v[248:251], v[64:79]
    ds_read_b128 v[48:51], v3 offset:14336
    s_waitcnt lgkmcnt(6)
    v_mfma_f32_32x32x16_bf16 v[80:95], v[248:251], v[56:59], v[80:95]
    ds_read_b128 v[52:55], v3 offset:17408
    s_waitcnt vmcnt(0) lgkmcnt(6)
    v_mfma_f32_32x32x16_bf16 v[64:79], v[60:63], v[252:255], v[64:79]
    ds_read_b128 v[56:59], v3 offset:20480
    s_waitcnt lgkmcnt(6)
    v_mfma_f32_32x32x16_bf16 v[80:95], v[252:255], v[32:35], v[80:95]
    ds_read_b128 v[60:63], v3 offset:23552
    s_waitcnt lgkmcnt(6)
    v_mfma_f32_32x32x16_bf16 v[64:79], v[36:39], v[24:27], v[64:79]
    ds_read_b128 v[32:35], v3 offset:26624
    s_waitcnt lgkmcnt(6)
    v_mfma_f32_32x32x16_bf16 v[80:95], v[24:27], v[40:43], v[80:95]
    ds_read_b128 v[36:39], v3 offset:29696
    s_waitcnt lgkmcnt(6)
    v_mfma_f32_32x32x16_bf16 v[96:111], v[44:47], v[228:231], v[96:111]
    s_nop 5
    v_mul_f32 v64, v28, v64
    v_mul_f32 v65, v28, v65
    v_mul_f32 v66, v28, v66
    v_mul_f32 v67, v28, v67
    v_mul_f32 v68, v28, v68
    v_mul_f32 v69, v28, v69
    ds_read_b128 v[40:43], v3 offset:32768
    s_waitcnt lgkmcnt(6)
    v_mfma_f32_32x32x16_bf16 v[96:111], v[48:51], v[232:235], v[96:111]
    v_mul_f32 v70, v28, v70
    v_mul_f32 v71, v28, v71
    v_cvt_pk_bf16_f32 v64, v64, v65
    v_cvt_pk_bf16_f32 v65, v66, v67
    v_cvt_pk_bf16_f32 v66, v68, v69
    v_cvt_pk_bf16_f32 v67, v70, v71
    s_waitcnt lgkmcnt(5)
    v_mfma_f32_32x32x16_bf16 v[96:111], v[52:55], v[236:239], v[96:111]
    ds_write_b128 v31, v[64:67] offset:0
    buffer_store_dwordx4 v[64:67], v1, s[56:59], s40 offen offset:0
    v_mul_f32 v72, v28, v72
    v_mul_f32 v73, v28, v73
    v_mul_f32 v74, v28, v74
    v_mul_f32 v75, v28, v75
    s_waitcnt lgkmcnt(5)
    v_mfma_f32_32x32x16_bf16 v[96:111], v[56:59], v[240:243], v[96:111]
    v_mul_f32 v76, v28, v76
    v_mul_f32 v77, v28, v77
    v_mul_f32 v78, v28, v78
    v_mul_f32 v79, v28, v79
    v_cvt_pk_bf16_f32 v72, v72, v73
    v_cvt_pk_bf16_f32 v73, v74, v75
    s_waitcnt lgkmcnt(4)
    v_mfma_f32_32x32x16_bf16 v[96:111], v[60:63], v[244:247], v[96:111]
    v_cvt_pk_bf16_f32 v74, v76, v77
    v_cvt_pk_bf16_f32 v75, v78, v79
    ds_write_b128 v31, v[72:75] offset:1024
    buffer_store_dwordx4 v[72:75], v1, s[56:59], s40 offen offset:1024
    s_waitcnt lgkmcnt(15)
    v_mul_f32 v80, v112, v80
    v_mul_f32 v81, v113, v81
    s_waitcnt lgkmcnt(4)
    v_mfma_f32_32x32x16_bf16 v[96:111], v[32:35], v[248:251], v[96:111]
    v_mul_f32 v82, v114, v82
    v_mul_f32 v83, v115, v83
    v_mul_f32 v84, v116, v84
    v_mul_f32 v85, v117, v85
    v_mul_f32 v86, v118, v86
    v_mul_f32 v87, v119, v87
    s_waitcnt lgkmcnt(3)
    v_mfma_f32_32x32x16_bf16 v[96:111], v[36:39], v[252:255], v[96:111]
    v_cvt_pk_bf16_f32 v80, v80, v81
    v_cvt_pk_bf16_f32 v81, v82, v83
    v_cvt_pk_bf16_f32 v82, v84, v85
    v_cvt_pk_bf16_f32 v83, v86, v87
    ds_write_b128 v31, v[80:83] offset:2048
    buffer_store_dwordx4 v[80:83], v30, s[56:59], s42 offen offset:0
    s_waitcnt lgkmcnt(3)
    v_mfma_f32_32x32x16_bf16 v[96:111], v[40:43], v[24:27], v[96:111]
    v_mul_f32 v88, v120, v88
    v_mul_f32 v89, v121, v89
    v_mul_f32 v90, v122, v90
    v_mul_f32 v91, v123, v91
    v_mul_f32 v92, v124, v92
    v_mul_f32 v93, v125, v93
    v_mul_f32 v94, v126, v94
    v_mul_f32 v95, v127, v95
    v_cvt_pk_bf16_f32 v88, v88, v89
    v_cvt_pk_bf16_f32 v89, v90, v91
    v_cvt_pk_bf16_f32 v90, v92, v93
    v_cvt_pk_bf16_f32 v91, v94, v95
    ds_write_b128 v31, v[88:91] offset:3072
    buffer_store_dwordx4 v[88:91], v30, s[56:59], s42 offen offset:512
    s_nop 0
    s_nop 0
    s_waitcnt lgkmcnt(0)
    s_barrier
mega_kernel_q_fin:
    s_nop 7
    s_nop 3
    v_mul_f32 v96, v29, v96
    v_mul_f32 v97, v29, v97
    v_mul_f32 v98, v29, v98
    v_mul_f32 v99, v29, v99
    v_mul_f32 v100, v29, v100
    v_mul_f32 v101, v29, v101
    v_mul_f32 v102, v29, v102
    v_mul_f32 v103, v29, v103
    v_cvt_pk_bf16_f32 v96, v96, v97
    v_cvt_pk_bf16_f32 v97, v98, v99
    v_cvt_pk_bf16_f32 v98, v100, v101
    v_cvt_pk_bf16_f32 v99, v102, v103
    buffer_store_dwordx4 v[96:99], v1, s[56:59], s44 offen offset:0
    v_mul_f32 v104, v29, v104
    v_mul_f32 v105, v29, v105
    v_mul_f32 v106, v29, v106
    v_mul_f32 v107, v29, v107
    v_mul_f32 v108, v29, v108
    v_mul_f32 v109, v29, v109
    v_mul_f32 v110, v29, v110
    v_mul_f32 v111, v29, v111
    v_cvt_pk_bf16_f32 v104, v104, v105
    v_cvt_pk_bf16_f32 v105, v106, v107
    v_cvt_pk_bf16_f32 v106, v108, v109
    v_cvt_pk_bf16_f32 v107, v110, v111
    buffer_store_dwordx4 v[104:107], v1, s[56:59], s44 offen offset:1024
    v_mov_b32 v8, 1
    s_mov_b64 exec, 1
    s_cmp_lg_u32 s15, 0
    s_waitcnt vmcnt(0)
    s_cbranch_scc1 mega_kernel_sig13a
    buffer_store_dword v8, off, s[8:11], s43
mega_kernel_sig13b:
    s_mov_b64 exec, -1
mega_kernel_att:
    s_lshl_b32 s36, s12, 4
    s_add_u32 s36, s36, s19
    s_lshl_b32 s36, s36, 7
    s_add_u32 s36, s36, 0x2000
    v_and_b32 v8, 7, v0
    v_lshlrev_b32 v8, 2, v8
    s_lshl_b32 s38, s12, 3
    s_lshl_b32 s39, s16, 1
    s_add_u32 s38, s38, s39
    s_add_u32 s33, s38, s17
    s_lshl_b32 s39, s13, 10
    s_add_u32 s39, s39, 0x240000
    s_mul_i32 s37, s33, 114688
    s_add_u32 s37, s37, s39
    s_xor_b32 s38, s33, 1
    s_mul_i32 s38, s38, 114688
    s_add_u32 s38, s38, s39
    s_lshl_b32 s41, s12, 3
    s_add_u32 s41, s41, s3
    s_mul_i32 s41, s41, 114688
    s_add_u32 s41, s41, s39
    s_add_u32 s41, s41, 0x8000
    s_add_u32 s42, s41, 0x8000
    s_lshl_b32 s39, s17, 13
    s_lshl_b32 s40, s16, 10
    s_add_u32 s39, s39, s40
    s_add_u32 m0, s39, 131072
    s_lshl_b32 s40, s13, 17
    v_mov_b32 v127, 0xdddd
    v_lshrrev_b32 v11, 1, v1
    v_xor_b32 v11, v11, v1
    v_and_b32 v11, 64, v11
    v_mul_u32_u24 v11, 3, v11
    v_xor_b32 v11, v11, v1
    v_mov_b32 v92, 0
    v_mov_b32 v93, 0
    v_mov_b32 v94, 0
    v_mov_b32 v95, 0
    v_mov_b32 v96, 0
    v_mov_b32 v97, 0
    v_mov_b32 v98, 0
    v_mov_b32 v99, 0
    v_mov_b32 v100, 0
    v_mov_b32 v101, 0
    v_mov_b32 v102, 0
    v_mov_b32 v103, 0
    v_mov_b32 v104, 0
    v_mov_b32 v105, 0
    v_mov_b32 v106, 0
    v_mov_b32 v107, 0
    v_mov_b32 v108, 0
    v_mov_b32 v109, 0
    v_mov_b32 v110, 0
    v_mov_b32 v111, 0
    v_mov_b32 v112, 0
    v_mov_b32 v113, 0
    v_mov_b32 v114, 0
    v_mov_b32 v115, 0
    v_mov_b32 v116, 0
    v_mov_b32 v117, 0
    v_mov_b32 v118, 0
    v_mov_b32 v119, 0
    v_mov_b32 v120, 0
    v_mov_b32 v121, 0
    v_mov_b32 v122, 0
    v_mov_b32 v123, 0
    s_mov_b32 s35, 0
mega_kernel_poll14:
    buffer_load_dword v9, v8, s[8:11], s36 offen sc1
    s_add_u32 s35, s35, 1
    s_cmp_gt_u32 s35, 20000
    s_cbranch_scc1 mega_kernel_end
    s_and_b32 s34, s35, s96
    s_cmp_eq_u32 s34, 63
    s_cbranch_scc1 mega_kernel_poll14s
    s_waitcnt vmcnt(0)
    v_cmp_ne_u32 vcc, 1, v9
    s_cbranch_vccnz mega_kernel_poll14
mega_kernel_poll14x:
    s_cmp_lg_u32 s15, 0
    s_cbranch_scc1 mega_kernel_poll14a
mega_kernel_poll14b:
    buffer_load_dwordx4 v1, s[56:59], s41 offen sc1 lds
    s_add_u32 m0, m0, 4096
    buffer_load_dwordx4 v[12:15], v1, s[56:59], s37 offen sc1
    buffer_load_dwordx4 v1, s[56:59], s42 offen sc1 lds
    buffer_load_dwordx4 v[16:19], v1, s[56:59], s38 offen sc1
    s_add_u32 s50, s37, 0x0
    s_lshl_b32 s39, s17, 13
    s_add_u32 s39, s39, 131072
    v_add_u32 v8, s39, v11
    v_and_b32 v9, 0x1ff, v2
    v_add_u32 v10, 159744, v9
    s_add_u32 s39, s39, 4096
    v_add_u32 v9, s39, v9
    v_and_b32 v124, 16, v0
    v_cmp_ne_u32 vcc, 0, v124
    s_nop 1
    v_cndmask_b32 v9, v9, v10
    v_mov_b32 v10, 0x4000
    v_cndmask_b32 v10, v10, 0, vcc
    s_lshl_b32 s43, s19, 2
    s_add_u32 s43, s43, s16
    s_lshl_b32 s43, s43, 7
    s_add_u32 s43, s43, 0x6000
    v_and_b32 v124, 15, v0
    v_lshlrev_b32 v124, 2, v124
    s_and_b32 s36, s16, 1
    s_lshl_b32 s36, s36, 10
    s_mul_i32 s44, s21, 65536
    s_add_u32 s44, s44, 0x360000
    s_add_u32 s44, s44, s36
    s_add_u32 s45, s44, 2048
    s_movk_i32 s46, 4096
    s_mul_i32 s47, s21, 231424
    s_mul_i32 s48, s16, 57344
    s_add_u32 s47, s47, s48
    s_add_u32 s47, s47, 0x3e0000
    s_add_u32 s48, s47, s36
    s_xor_b32 s36, s36, 1024
    s_add_u32 s49, s47, s36
    s_add_u32 s48, s48, 6144
    s_add_u32 s49, s49, 6144
    s_cmp_eq_u32 s17, 0
    s_cselect_b32 s44, s44, s48
    s_cselect_b32 s45, s45, s49
    s_cselect_b32 s48, s46, 8192
    s_cselect_b32 s46, s46, 2048
    s_mul_i32 s36, s19, 118272
    s_add_u32 s36, s36, 0x190000
    v_add_u32 v125, s36, v1
    s_lshl_b32 s99, s14, 3
    s_add_u32 s99, s99, s3
    s_cmp_eq_u32 s99, 7
    s_waitcnt vmcnt(0)
    s_barrier
    buffer_load_dword v126, v124, s[8:11], s43 offen sc1
    s_add_u32 s40, s40, 0x10000
    s_add_u32 s41, s12, s17
    s_add_u32 s41, s41, 1
    s_and_b32 s41, s41, 7
    s_lshl_b32 s41, s41, 14
    s_add_u32 s41, s41, s40
    s_lshl_b32 s42, s16, 10
    s_add_u32 s41, s41, s42
    s_lshl_b32 s55, s17, 14
    s_add_u32 s42, s42, s55
    s_add_u32 s42, s42, 0x4000
    s_mov_b32 s55, 0
    s_lshr_b32 s36, s99, 2
    s_cmp_eq_u32 s36, 1
    s_cselect_b64 exec, -1, 0
    s_lshl_b32 m0, s16, 12
    buffer_load_ushort v205, v204, s[76:79], 0 offen
    buffer_load_dwordx4 v200, s[72:75], 0 offen offset:0 lds
    buffer_load_dwordx4 v201, s[72:75], 0 offen offset:1024 lds
    buffer_load_dwordx4 v202, s[72:75], 0 offen offset:2048 lds
    buffer_load_dwordx4 v203, s[72:75], 0 offen offset:3072 lds
    s_mov_b64 exec, -1
    ds_read_b128 v[20:23], v8 offset:0
    ds_read_b128 v[24:27], v8 offset:1024
    ds_read_b128 v[28:31], v9 offset:0
    ds_read_b128 v[32:35], v9 offset:512
    s_waitcnt lgkmcnt(3)
    v_mfma_f32_32x32x16_bf16 v[44:59], v[20:23], v[12:15], 0
    v_mfma_f32_32x32x16_bf16 v[60:75], v[20:23], v[16:19], 0
    s_setprio 3
    s_nop 7
    s_nop 1
    v_exp_f32 v44, v44
    v_exp_f32 v45, v45
    v_exp_f32 v46, v46
    v_exp_f32 v47, v47
    v_exp_f32 v48, v48
    v_exp_f32 v49, v49
    v_exp_f32 v50, v50
    v_exp_f32 v51, v51
    v_exp_f32 v52, v52
    v_exp_f32 v53, v53
    v_exp_f32 v54, v54
    v_exp_f32 v55, v55
    v_exp_f32 v56, v56
    v_exp_f32 v57, v57
    v_exp_f32 v58, v58
    v_exp_f32 v59, v59
    s_waitcnt lgkmcnt(0)
    v_mfma_f32_32x32x16_bf16 v[76:91], v[24:27], v[12:15], 0
    ds_read_b128 v[20:23], v8 offset:2048
    ds_read_b128 v[36:39], v9 offset:1024
    ds_read_b128 v[40:43], v9 offset:1536
    v_exp_f32 v60, v60
    v_exp_f32 v61, v61
    v_exp_f32 v62, v62
    v_exp_f32 v63, v63
    v_exp_f32 v64, v64
    v_smfmac_f32_32x32x32_bf16 v[92:107], v[28:31], v[44:51], v127
    v_exp_f32 v65, v65
    v_exp_f32 v66, v66
    v_exp_f32 v67, v67
    v_exp_f32 v68, v68
    v_exp_f32 v69, v69
    v_smfmac_f32_32x32x32_bf16 v[92:107], v[32:35], v[52:59], v127
    v_exp_f32 v70, v70
    v_exp_f32 v71, v71
    v_exp_f32 v72, v72
    v_exp_f32 v73, v73
    v_exp_f32 v74, v74
    v_exp_f32 v75, v75
    v_mfma_f32_32x32x16_bf16 v[44:59], v[24:27], v[16:19], 0
    v_exp_f32 v76, v76
    v_exp_f32 v77, v77
    v_exp_f32 v78, v78
    v_exp_f32 v79, v79
    v_exp_f32 v80, v80
    v_smfmac_f32_32x32x32_bf16 v[108:123], v[28:31], v[60:67], v127
    v_exp_f32 v81, v81
    v_exp_f32 v82, v82
    v_exp_f32 v83, v83
    v_exp_f32 v84, v84
    v_exp_f32 v85, v85
    v_smfmac_f32_32x32x32_bf16 v[108:123], v[32:35], v[68:75], v127
    s_waitcnt lgkmcnt(0)
    v_exp_f32 v86, v86
    v_exp_f32 v87, v87
    v_exp_f32 v88, v88
    v_exp_f32 v89, v89
    v_exp_f32 v90, v90
    v_exp_f32 v91, v91
    s_waitcnt vmcnt(5)
    v_cmp_ne_u32 vcc, 1, v126
    s_cbranch_vccnz mega_kernel_a_late
    s_mov_b32 s55, 1
    s_mov_b32 m0, s42
    s_nop 0
    buffer_load_dwordx4 v1, s[8:11], s41 offen sc1 lds
    s_add_u32 m0, m0, 4096
    s_add_u32 s41, s41, 4096
    buffer_load_dwordx4 v1, s[8:11], s41 offen sc1 lds
    s_add_u32 m0, m0, 4096
    s_add_u32 s41, s41, 4096
    buffer_load_dwordx4 v1, s[8:11], s41 offen sc1 lds
    s_add_u32 m0, m0, 4096
    s_add_u32 s41, s41, 4096
    buffer_load_dwordx4 v1, s[8:11], s41 offen sc1 lds
mega_kernel_a_late:
    v_mfma_f32_32x32x16_bf16 v[60:75], v[20:23], v[12:15], 0
    ds_read_b128 v[24:27], v8 offset:3072
    ds_read_b128 v[28:31], v9 offset:2048
    ds_read_b128 v[32:35], v9 offset:2560
    v_exp_f32 v44, v44
    v_exp_f32 v45, v45
    v_exp_f32 v46, v46
    v_exp_f32 v47, v47
    v_exp_f32 v48, v48
    v_smfmac_f32_32x32x32_bf16 v[92:107], v[36:39], v[76:83], v127
    v_exp_f32 v49, v49
    v_exp_f32 v50, v50
    v_exp_f32 v51, v51
    v_exp_f32 v52, v52
    v_exp_f32 v53, v53
    v_smfmac_f32_32x32x32_bf16 v[92:107], v[40:43], v[84:91], v127
    v_exp_f32 v54, v54
    v_exp_f32 v55, v55
    v_exp_f32 v56, v56
    v_exp_f32 v57, v57
    v_exp_f32 v58, v58
    v_exp_f32 v59, v59
    v_mfma_f32_32x32x16_bf16 v[76:91], v[20:23], v[16:19], 0
    v_exp_f32 v60, v60
    v_exp_f32 v61, v61
    v_exp_f32 v62, v62
    v_exp_f32 v63, v63
    v_exp_f32 v64, v64
    v_smfmac_f32_32x32x32_bf16 v[108:123], v[36:39], v[44:51], v127
    v_exp_f32 v65, v65
    v_exp_f32 v66, v66
    v_exp_f32 v67, v67
    v_exp_f32 v68, v68
    v_exp_f32 v69, v69
    v_smfmac_f32_32x32x32_bf16 v[108:123], v[40:43], v[52:59], v127
    s_waitcnt lgkmcnt(0)
    v_exp_f32 v70, v70
    v_exp_f32 v71, v71
    v_exp_f32 v72, v72
    v_exp_f32 v73, v73
    v_exp_f32 v74, v74
    v_exp_f32 v75, v75
    v_mfma_f32_32x32x16_bf16 v[44:59], v[24:27], v[12:15], 0
    ds_read_b128 v[36:39], v9 offset:3072
    ds_read_b128 v[40:43], v9 offset:3584
    v_exp_f32 v76, v76
    v_exp_f32 v77, v77
    v_exp_f32 v78, v78
    v_exp_f32 v79, v79
    v_exp_f32 v80, v80
    v_smfmac_f32_32x32x32_bf16 v[92:107], v[28:31], v[60:67], v127
    v_exp_f32 v81, v81
    v_exp_f32 v82, v82
    v_exp_f32 v83, v83
    v_exp_f32 v84, v84
    v_exp_f32 v85, v85
    v_smfmac_f32_32x32x32_bf16 v[92:107], v[32:35], v[68:75], v127
    v_exp_f32 v86, v86
    v_exp_f32 v87, v87
    v_exp_f32 v88, v88
    v_exp_f32 v89, v89
    v_exp_f32 v90, v90
    v_exp_f32 v91, v91
    v_mfma_f32_32x32x16_bf16 v[60:75], v[24:27], v[16:19], 0
    v_exp_f32 v44, v44
    v_exp_f32 v45, v45
    v_exp_f32 v46, v46
    v_exp_f32 v47, v47
    v_exp_f32 v48, v48
    v_smfmac_f32_32x32x32_bf16 v[108:123], v[28:31], v[76:83], v127
    s_setprio 2
    v_exp_f32 v49, v49
    v_exp_f32 v50, v50
    v_exp_f32 v51, v51
    v_exp_f32 v52, v52
    v_exp_f32 v53, v53
    v_smfmac_f32_32x32x32_bf16 v[108:123], v[32:35], v[84:91], v127
    s_waitcnt lgkmcnt(0)
    v_exp_f32 v54, v54
    v_exp_f32 v55, v55
    v_exp_f32 v56, v56
    v_exp_f32 v57, v57
    v_exp_f32 v58, v58
    v_exp_f32 v59, v59
    v_exp_f32 v60, v60
    v_exp_f32 v61, v61
    v_exp_f32 v62, v62
    v_exp_f32 v63, v63
    v_exp_f32 v64, v64
    v_smfmac_f32_32x32x32_bf16 v[92:107], v[36:39], v[44:51], v127
    s_setprio 1
    v_exp_f32 v65, v65
    v_exp_f32 v66, v66
    v_exp_f32 v67, v67
    v_exp_f32 v68, v68
    v_exp_f32 v69, v69
    v_smfmac_f32_32x32x32_bf16 v[92:107], v[40:43], v[52:59], v127
    s_setprio 0
    v_exp_f32 v70, v70
    v_exp_f32 v71, v71
    v_exp_f32 v72, v72
    v_exp_f32 v73, v73
    v_exp_f32 v74, v74
    v_exp_f32 v75, v75
    v_smfmac_f32_32x32x32_bf16 v[108:123], v[36:39], v[60:67], v127
    s_nop 0
    v_smfmac_f32_32x32x32_bf16 v[108:123], v[40:43], v[68:75], v127
    s_cmp_eq_u32 s55, 0
    s_cbranch_scc1 mega_kernel_a_poll
mega_kernel_a_polled:
    v_add_u32 v8, 0xfffe4000, v8
    v_mad_i32_i24 v9, v10, -7, v9
    s_mul_i32 s51, s18, 114688
    s_mul_i32 s52, s19, 7168
    s_add_u32 s51, s51, s52
    s_add_u32 s51, s51, 0x240000
    s_add_u32 s52, s51, 3584
    s_add_u32 s53, s22, 0x0
    s_add_u32 s54, s23, 0x200000
    v_mul_u32_u24 v11, 56, v0
    v_mov_b32 v124, v11
    s_cmp_eq_u32 s17, 0
    s_cselect_b32 s51, s53, s51
    s_cselect_b32 s52, s54, s52
    s_cselect_b64 exec, -1, 0
    v_lshlrev_b32 v11, 5, v0
    v_mov_b32 v124, v5
    s_mov_b64 exec, -1
    s_and_b32 s54, s22, 0x7fff
    s_sub_u32 s53, s22, s54
    s_lshr_b32 s54, s54, 5
    s_add_u32 s53, s53, s54
    s_lshl_b32 s54, s17, 5
    s_add_u32 s53, s53, s54
    s_lshl_b32 s54, s17, 10
    s_add_u32 s36, s54, s22
    s_add_u32 s36, s36, 0x0
    s_lshl_b32 s37, s16, 11
    s_add_u32 s54, s54, s37
    s_add_u32 s54, s54, 151552
    v_mov_b32 v126, v1
    s_cmp_eq_u32 s14, 0
    s_cselect_b32 s53, s53, s36
    s_cselect_b64 s[72:73], s[64:65], s[56:57]
    s_cselect_b32 s74, s66, s58
    s_cselect_b64 exec, -1, 0
    v_and_b32 v20, 31, v0
    v_lshrrev_b32 v21, 5, v0
    v_lshlrev_b32 v20, 10, v20
    v_lshl_add_u32 v126, v21, 4, v20
    s_mov_b64 exec, -1
    s_cmp_eq_u32 s17, 0
    s_cbranch_scc0 mega_kernel_a_now
    s_waitcnt vmcnt(0)
mega_kernel_a_now:
    s_waitcnt vmcnt(4)
    s_barrier
    s_lshr_b32 s36, s99, 2
    s_cmp_eq_u32 s36, 1
    s_cbranch_scc1 mega_kernel_cvd
mega_kernel_cvdd:
    s_lshl_b32 s42, s3, 11
    s_add_u32 s40, s40, s42
    ds_read_b128 v[20:23], v8 offset:0
    ds_read_b128 v[24:27], v8 offset:1024
    ds_read_b128 v[28:31], v9 offset:0
    ds_read_b128 v[32:35], v9 offset:512
    s_waitcnt lgkmcnt(3)
    v_mfma_f32_32x32x16_bf16 v[44:59], v[20:23], v[12:15], 0
    v_mfma_f32_32x32x16_bf16 v[60:75], v[20:23], v[16:19], 0
    s_setprio 3
    s_add_u32 s41, s12, 3
    s_and_b32 s41, s41, 7
    s_lshl_b32 s41, s41, 14
    s_nop 6
    v_exp_f32 v44, v44
    v_exp_f32 v45, v45
    v_exp_f32 v46, v46
    v_exp_f32 v47, v47
    v_exp_f32 v48, v48
    s_add_u32 s41, s41, s40
    s_add_u32 m0, s42, 49152
    v_exp_f32 v49, v49
    v_exp_f32 v50, v50
    v_exp_f32 v51, v51
    v_exp_f32 v52, v52
    v_exp_f32 v53, v53
    buffer_load_dwordx4 v1, s[8:11], s41 offen offset:0 sc1 lds
    v_exp_f32 v54, v54
    v_exp_f32 v55, v55
    v_exp_f32 v56, v56
    v_exp_f32 v57, v57
    v_exp_f32 v58, v58
    v_exp_f32 v59, v59
    s_waitcnt lgkmcnt(0)
    v_mfma_f32_32x32x16_bf16 v[76:91], v[24:27], v[12:15], 0
    ds_read_b128 v[20:23], v8 offset:2048
    ds_read_b128 v[36:39], v9 offset:1024
    ds_read_b128 v[40:43], v9 offset:1536
    v_exp_f32 v60, v60
    v_exp_f32 v61, v61
    v_exp_f32 v62, v62
    v_exp_f32 v63, v63
    v_exp_f32 v64, v64
    v_smfmac_f32_32x32x32_bf16 v[92:107], v[28:31], v[44:51], v127
    v_exp_f32 v65, v65
    v_exp_f32 v66, v66
    v_exp_f32 v67, v67
    v_exp_f32 v68, v68
    v_exp_f32 v69, v69
    v_smfmac_f32_32x32x32_bf16 v[92:107], v[32:35], v[52:59], v127
    buffer_load_dwordx4 v1, s[8:11], s41 offen offset:1024 sc1 lds
    v_exp_f32 v70, v70
    v_exp_f32 v71, v71
    v_exp_f32 v72, v72
    v_exp_f32 v73, v73
    v_exp_f32 v74, v74
    v_exp_f32 v75, v75
    v_mfma_f32_32x32x16_bf16 v[44:59], v[24:27], v[16:19], 0
    v_exp_f32 v76, v76
    v_exp_f32 v77, v77
    v_exp_f32 v78, v78
    v_exp_f32 v79, v79
    v_exp_f32 v80, v80
    v_smfmac_f32_32x32x32_bf16 v[108:123], v[28:31], v[60:67], v127
    v_exp_f32 v81, v81
    v_exp_f32 v82, v82
    v_exp_f32 v83, v83
    v_exp_f32 v84, v84
    v_exp_f32 v85, v85
    v_smfmac_f32_32x32x32_bf16 v[108:123], v[32:35], v[68:75], v127
    s_waitcnt lgkmcnt(0)
    v_exp_f32 v86, v86
    v_exp_f32 v87, v87
    v_exp_f32 v88, v88
    v_exp_f32 v89, v89
    v_exp_f32 v90, v90
    v_exp_f32 v91, v91
    v_mfma_f32_32x32x16_bf16 v[60:75], v[20:23], v[12:15], 0
    ds_read_b128 v[24:27], v8 offset:3072
    ds_read_b128 v[28:31], v9 offset:2048
    ds_read_b128 v[32:35], v9 offset:2560
    v_exp_f32 v44, v44
    v_exp_f32 v45, v45
    v_exp_f32 v46, v46
    v_exp_f32 v47, v47
    v_exp_f32 v48, v48
    v_smfmac_f32_32x32x32_bf16 v[92:107], v[36:39], v[76:83], v127
    s_mov_b32 m0, s54
    v_exp_f32 v49, v49
    v_exp_f32 v50, v50
    v_exp_f32 v51, v51
    v_exp_f32 v52, v52
    v_exp_f32 v53, v53
    v_smfmac_f32_32x32x32_bf16 v[92:107], v[40:43], v[84:91], v127
    buffer_load_dwordx4 v126, s[72:75], s53 offen sc1 lds
    v_exp_f32 v54, v54
    v_exp_f32 v55, v55
    v_exp_f32 v56, v56
    v_exp_f32 v57, v57
    v_exp_f32 v58, v58
    v_exp_f32 v59, v59
    v_mfma_f32_32x32x16_bf16 v[76:91], v[20:23], v[16:19], 0
    s_setprio 2
    s_add_u32 s41, s12, 4
    s_and_b32 s41, s41, 7
    s_lshl_b32 s41, s41, 14
    v_exp_f32 v60, v60
    v_exp_f32 v61, v61
    v_exp_f32 v62, v62
    v_exp_f32 v63, v63
    v_exp_f32 v64, v64
    v_smfmac_f32_32x32x32_bf16 v[108:123], v[36:39], v[44:51], v127
    s_setprio 1
    s_add_u32 s41, s41, s40
    s_add_u32 m0, s42, 65536
    v_exp_f32 v65, v65
    v_exp_f32 v66, v66
    v_exp_f32 v67, v67
    v_exp_f32 v68, v68
    v_exp_f32 v69, v69
    v_smfmac_f32_32x32x32_bf16 v[108:123], v[40:43], v[52:59], v127
    s_setprio 0
    s_waitcnt lgkmcnt(0)
    buffer_load_dwordx4 v1, s[8:11], s41 offen offset:0 sc1 lds
    v_exp_f32 v70, v70
    v_exp_f32 v71, v71
    v_exp_f32 v72, v72
    v_exp_f32 v73, v73
    v_exp_f32 v74, v74
    v_exp_f32 v75, v75
    s_waitcnt vmcnt(4)
    s_barrier
    s_cmp_eq_u32 s99, 7
    s_cbranch_scc1 mega_kernel_fwr
mega_kernel_fwrd:
    v_mfma_f32_32x32x16_bf16 v[44:59], v[24:27], v[12:15], 0
    s_setprio 3
    v_add_u32 v8, 0x4000, v8
    ds_read_b128 v[20:23], v8 offset:0
    ds_read_b128 v[36:39], v9 offset:3072
    ds_read_b128 v[40:43], v9 offset:3584
    v_exp_f32 v76, v76
    v_exp_f32 v77, v77
    v_exp_f32 v78, v78
    v_exp_f32 v79, v79
    v_exp_f32 v80, v80
    v_smfmac_f32_32x32x32_bf16 v[92:107], v[28:31], v[60:67], v127
    v_exp_f32 v81, v81
    v_exp_f32 v82, v82
    v_exp_f32 v83, v83
    v_exp_f32 v84, v84
    v_exp_f32 v85, v85
    v_smfmac_f32_32x32x32_bf16 v[92:107], v[32:35], v[68:75], v127
    buffer_load_dwordx4 v1, s[8:11], s41 offen offset:1024 sc1 lds
    v_exp_f32 v86, v86
    v_exp_f32 v87, v87
    v_exp_f32 v88, v88
    v_exp_f32 v89, v89
    v_exp_f32 v90, v90
    v_exp_f32 v91, v91
    v_mfma_f32_32x32x16_bf16 v[60:75], v[24:27], v[16:19], 0
    v_exp_f32 v44, v44
    v_exp_f32 v45, v45
    v_exp_f32 v46, v46
    v_exp_f32 v47, v47
    v_exp_f32 v48, v48
    v_smfmac_f32_32x32x32_bf16 v[108:123], v[28:31], v[76:83], v127
    v_exp_f32 v49, v49
    v_exp_f32 v50, v50
    v_exp_f32 v51, v51
    v_exp_f32 v52, v52
    v_exp_f32 v53, v53
    v_smfmac_f32_32x32x32_bf16 v[108:123], v[32:35], v[84:91], v127
    s_waitcnt lgkmcnt(0)
    v_exp_f32 v54, v54
    v_exp_f32 v55, v55
    v_exp_f32 v56, v56
    v_exp_f32 v57, v57
    v_exp_f32 v58, v58
    v_exp_f32 v59, v59
    v_mfma_f32_32x32x16_bf16 v[76:91], v[20:23], v[12:15], 0
    ds_read_b128 v[24:27], v8 offset:1024
    v_add_u32 v9, v10, v9
    ds_read_b128 v[28:31], v9 offset:0
    ds_read_b128 v[32:35], v9 offset:512
    v_exp_f32 v60, v60
    v_exp_f32 v61, v61
    v_exp_f32 v62, v62
    v_exp_f32 v63, v63
    v_exp_f32 v64, v64
    v_smfmac_f32_32x32x32_bf16 v[92:107], v[36:39], v[44:51], v127
    v_exp_f32 v65, v65
    v_exp_f32 v66, v66
    v_exp_f32 v67, v67
    v_exp_f32 v68, v68
    v_exp_f32 v69, v69
    v_smfmac_f32_32x32x32_bf16 v[92:107], v[40:43], v[52:59], v127
    v_exp_f32 v70, v70
    v_exp_f32 v71, v71
    v_exp_f32 v72, v72
    v_exp_f32 v73, v73
    v_exp_f32 v74, v74
    v_exp_f32 v75, v75
    v_mfma_f32_32x32x16_bf16 v[44:59], v[20:23], v[16:19], 0
    s_add_u32 s41, s12, 5
    s_and_b32 s41, s41, 7
    s_lshl_b32 s41, s41, 14
    v_exp_f32 v76, v76
    v_exp_f32 v77, v77
    v_exp_f32 v78, v78
    v_exp_f32 v79, v79
    v_exp_f32 v80, v80
    v_smfmac_f32_32x32x32_bf16 v[108:123], v[36:39], v[60:67], v127
    s_add_u32 s41, s41, s40
    s_add_u32 m0, s42, 81920
    v_exp_f32 v81, v81
    v_exp_f32 v82, v82
    v_exp_f32 v83, v83
    v_exp_f32 v84, v84
    v_exp_f32 v85, v85
    v_smfmac_f32_32x32x32_bf16 v[108:123], v[40:43], v[68:75], v127
    s_waitcnt lgkmcnt(0)
    buffer_load_dwordx4 v1, s[8:11], s41 offen offset:0 sc1 lds
    v_exp_f32 v86, v86
    v_exp_f32 v87, v87
    v_exp_f32 v88, v88
    v_exp_f32 v89, v89
    v_exp_f32 v90, v90
    v_exp_f32 v91, v91
    v_mfma_f32_32x32x16_bf16 v[60:75], v[24:27], v[12:15], 0
    ds_read_b128 v[20:23], v8 offset:2048
    ds_read_b128 v[36:39], v9 offset:1024
    ds_read_b128 v[40:43], v9 offset:1536
    v_exp_f32 v44, v44
    v_exp_f32 v45, v45
    v_exp_f32 v46, v46
    v_exp_f32 v47, v47
    v_exp_f32 v48, v48
    v_smfmac_f32_32x32x32_bf16 v[92:107], v[28:31], v[76:83], v127
    v_exp_f32 v49, v49
    v_exp_f32 v50, v50
    v_exp_f32 v51, v51
    v_exp_f32 v52, v52
    v_exp_f32 v53, v53
    v_smfmac_f32_32x32x32_bf16 v[92:107], v[32:35], v[84:91], v127
    buffer_load_dwordx4 v1, s[8:11], s41 offen offset:1024 sc1 lds
    v_exp_f32 v54, v54
    v_exp_f32 v55, v55
    v_exp_f32 v56, v56
    v_exp_f32 v57, v57
    v_exp_f32 v58, v58
    v_exp_f32 v59, v59
    v_mfma_f32_32x32x16_bf16 v[76:91], v[24:27], v[16:19], 0
    v_exp_f32 v60, v60
    v_exp_f32 v61, v61
    v_exp_f32 v62, v62
    v_exp_f32 v63, v63
    v_exp_f32 v64, v64
    v_smfmac_f32_32x32x32_bf16 v[108:123], v[28:31], v[44:51], v127
    v_exp_f32 v65, v65
    v_exp_f32 v66, v66
    v_exp_f32 v67, v67
    v_exp_f32 v68, v68
    v_exp_f32 v69, v69
    v_smfmac_f32_32x32x32_bf16 v[108:123], v[32:35], v[52:59], v127
    s_waitcnt lgkmcnt(0)
    v_exp_f32 v70, v70
    v_exp_f32 v71, v71
    v_exp_f32 v72, v72
    v_exp_f32 v73, v73
    v_exp_f32 v74, v74
    v_exp_f32 v75, v75
    v_mfma_f32_32x32x16_bf16 v[44:59], v[20:23], v[12:15], 0
    ds_read_b128 v[24:27], v8 offset:3072
    ds_read_b128 v[28:31], v9 offset:2048
    ds_read_b128 v[32:35], v9 offset:2560
    v_exp_f32 v76, v76
    v_exp_f32 v77, v77
    v_exp_f32 v78, v78
    v_exp_f32 v79, v79
    v_exp_f32 v80, v80
    v_smfmac_f32_32x32x32_bf16 v[92:107], v[36:39], v[60:67], v127
    s_setprio 2
    v_exp_f32 v81, v81
    v_exp_f32 v82, v82
    v_exp_f32 v83, v83
    v_exp_f32 v84, v84
    v_exp_f32 v85, v85
    v_smfmac_f32_32x32x32_bf16 v[92:107], v[40:43], v[68:75], v127
    v_exp_f32 v86, v86
    v_exp_f32 v87, v87
    v_exp_f32 v88, v88
    v_exp_f32 v89, v89
    v_exp_f32 v90, v90
    v_exp_f32 v91, v91
    v_mfma_f32_32x32x16_bf16 v[60:75], v[20:23], v[16:19], 0
    s_add_u32 s41, s12, 6
    s_and_b32 s41, s41, 7
    s_lshl_b32 s41, s41, 14
    v_exp_f32 v44, v44
    v_exp_f32 v45, v45
    v_exp_f32 v46, v46
    v_exp_f32 v47, v47
    v_exp_f32 v48, v48
    v_smfmac_f32_32x32x32_bf16 v[108:123], v[36:39], v[76:83], v127
    s_setprio 1
    s_add_u32 s41, s41, s40
    s_add_u32 m0, s42, 98304
    v_exp_f32 v49, v49
    v_exp_f32 v50, v50
    v_exp_f32 v51, v51
    v_exp_f32 v52, v52
    v_exp_f32 v53, v53
    v_smfmac_f32_32x32x32_bf16 v[108:123], v[40:43], v[84:91], v127
    s_setprio 0
    s_waitcnt lgkmcnt(0)
    buffer_load_dwordx4 v1, s[8:11], s41 offen offset:0 sc1 lds
    v_exp_f32 v54, v54
    v_exp_f32 v55, v55
    v_exp_f32 v56, v56
    v_exp_f32 v57, v57
    v_exp_f32 v58, v58
    v_exp_f32 v59, v59
    s_waitcnt vmcnt(6)
    s_barrier
    v_mfma_f32_32x32x16_bf16 v[76:91], v[24:27], v[12:15], 0
    s_setprio 3
    v_add_u32 v8, 0x4000, v8
    ds_read_b128 v[20:23], v8 offset:0
    ds_read_b128 v[36:39], v9 offset:3072
    ds_read_b128 v[40:43], v9 offset:3584
    v_exp_f32 v60, v60
    v_exp_f32 v61, v61
    v_exp_f32 v62, v62
    v_exp_f32 v63, v63
    v_exp_f32 v64, v64
    v_smfmac_f32_32x32x32_bf16 v[92:107], v[28:31], v[44:51], v127
    v_exp_f32 v65, v65
    v_exp_f32 v66, v66
    v_exp_f32 v67, v67
    v_exp_f32 v68, v68
    v_exp_f32 v69, v69
    v_smfmac_f32_32x32x32_bf16 v[92:107], v[32:35], v[52:59], v127
    buffer_load_dwordx4 v1, s[8:11], s41 offen offset:1024 sc1 lds
    v_exp_f32 v70, v70
    v_exp_f32 v71, v71
    v_exp_f32 v72, v72
    v_exp_f32 v73, v73
    v_exp_f32 v74, v74
    v_exp_f32 v75, v75
    v_mfma_f32_32x32x16_bf16 v[44:59], v[24:27], v[16:19], 0
    v_exp_f32 v76, v76
    v_exp_f32 v77, v77
    v_exp_f32 v78, v78
    v_exp_f32 v79, v79
    v_exp_f32 v80, v80
    v_smfmac_f32_32x32x32_bf16 v[108:123], v[28:31], v[60:67], v127
    v_exp_f32 v81, v81
    v_exp_f32 v82, v82
    v_exp_f32 v83, v83
    v_exp_f32 v84, v84
    v_exp_f32 v85, v85
    v_smfmac_f32_32x32x32_bf16 v[108:123], v[32:35], v[68:75], v127
    s_waitcnt lgkmcnt(0)
    v_exp_f32 v86, v86
    v_exp_f32 v87, v87
    v_exp_f32 v88, v88
    v_exp_f32 v89, v89
    v_exp_f32 v90, v90
    v_exp_f32 v91, v91
    v_mfma_f32_32x32x16_bf16 v[60:75], v[20:23], v[12:15], 0
    ds_read_b128 v[24:27], v8 offset:1024
    v_add_u32 v9, v10, v9
    ds_read_b128 v[28:31], v9 offset:0
    ds_read_b128 v[32:35], v9 offset:512
    v_exp_f32 v44, v44
    v_exp_f32 v45, v45
    v_exp_f32 v46, v46
    v_exp_f32 v47, v47
    v_exp_f32 v48, v48
    v_smfmac_f32_32x32x32_bf16 v[92:107], v[36:39], v[76:83], v127
    v_exp_f32 v49, v49
    v_exp_f32 v50, v50
    v_exp_f32 v51, v51
    v_exp_f32 v52, v52
    v_exp_f32 v53, v53
    v_smfmac_f32_32x32x32_bf16 v[92:107], v[40:43], v[84:91], v127
    v_exp_f32 v54, v54
    v_exp_f32 v55, v55
    v_exp_f32 v56, v56
    v_exp_f32 v57, v57
    v_exp_f32 v58, v58
    v_exp_f32 v59, v59
    v_mfma_f32_32x32x16_bf16 v[76:91], v[20:23], v[16:19], 0
    s_add_u32 s41, s12, 7
    s_and_b32 s41, s41, 7
    s_lshl_b32 s41, s41, 14
    v_exp_f32 v60, v60
    v_exp_f32 v61, v61
    v_exp_f32 v62, v62
    v_exp_f32 v63, v63
    v_exp_f32 v64, v64
    v_smfmac_f32_32x32x32_bf16 v[108:123], v[36:39], v[44:51], v127
    s_add_u32 s41, s41, s40
    s_add_u32 m0, s42, 114688
    v_exp_f32 v65, v65
    v_exp_f32 v66, v66
    v_exp_f32 v67, v67
    v_exp_f32 v68, v68
    v_exp_f32 v69, v69
    v_smfmac_f32_32x32x32_bf16 v[108:123], v[40:43], v[52:59], v127
    s_waitcnt lgkmcnt(0)
    buffer_load_dwordx4 v1, s[8:11], s41 offen offset:0 sc1 lds
    v_exp_f32 v70, v70
    v_exp_f32 v71, v71
    v_exp_f32 v72, v72
    v_exp_f32 v73, v73
    v_exp_f32 v74, v74
    v_exp_f32 v75, v75
    v_mfma_f32_32x32x16_bf16 v[44:59], v[24:27], v[12:15], 0
    ds_read_b128 v[20:23], v8 offset:2048
    ds_read_b128 v[36:39], v9 offset:1024
    ds_read_b128 v[40:43], v9 offset:1536
    v_exp_f32 v76, v76
    v_exp_f32 v77, v77
    v_exp_f32 v78, v78
    v_exp_f32 v79, v79
    v_exp_f32 v80, v80
    v_smfmac_f32_32x32x32_bf16 v[92:107], v[28:31], v[60:67], v127
    v_exp_f32 v81, v81
    v_exp_f32 v82, v82
    v_exp_f32 v83, v83
    v_exp_f32 v84, v84
    v_exp_f32 v85, v85
    v_smfmac_f32_32x32x32_bf16 v[92:107], v[32:35], v[68:75], v127
    buffer_load_dwordx4 v1, s[8:11], s41 offen offset:1024 sc1 lds
    v_exp_f32 v86, v86
    v_exp_f32 v87, v87
    v_exp_f32 v88, v88
    v_exp_f32 v89, v89
    v_exp_f32 v90, v90
    v_exp_f32 v91, v91
    v_mfma_f32_32x32x16_bf16 v[60:75], v[24:27], v[16:19], 0
    v_exp_f32 v44, v44
    v_exp_f32 v45, v45
    v_exp_f32 v46, v46
    v_exp_f32 v47, v47
    v_exp_f32 v48, v48
    v_smfmac_f32_32x32x32_bf16 v[108:123], v[28:31], v[76:83], v127
    v_exp_f32 v49, v49
    v_exp_f32 v50, v50
    v_exp_f32 v51, v51
    v_exp_f32 v52, v52
    v_exp_f32 v53, v53
    v_smfmac_f32_32x32x32_bf16 v[108:123], v[32:35], v[84:91], v127
    s_waitcnt lgkmcnt(0)
    s_cmp_eq_u32 s99, 7
    s_cbranch_scc1 mega_kernel_fwl
mega_kernel_fwld:
    v_exp_f32 v54, v54
    v_exp_f32 v55, v55
    v_exp_f32 v56, v56
    v_exp_f32 v57, v57
    v_exp_f32 v58, v58
    v_exp_f32 v59, v59
    v_mfma_f32_32x32x16_bf16 v[76:91], v[20:23], v[12:15], 0
    ds_read_b128 v[24:27], v8 offset:3072
    ds_read_b128 v[28:31], v9 offset:2048
    ds_read_b128 v[32:35], v9 offset:2560
    v_exp_f32 v60, v60
    v_exp_f32 v61, v61
    v_exp_f32 v62, v62
    v_exp_f32 v63, v63
    v_exp_f32 v64, v64
    v_smfmac_f32_32x32x32_bf16 v[92:107], v[36:39], v[44:51], v127
    s_setprio 2
    v_exp_f32 v65, v65
    v_exp_f32 v66, v66
    v_exp_f32 v67, v67
    v_exp_f32 v68, v68
    v_exp_f32 v69, v69
    v_smfmac_f32_32x32x32_bf16 v[92:107], v[40:43], v[52:59], v127
    v_exp_f32 v70, v70
    v_exp_f32 v71, v71
    v_exp_f32 v72, v72
    v_exp_f32 v73, v73
    v_exp_f32 v74, v74
    v_exp_f32 v75, v75
    v_mfma_f32_32x32x16_bf16 v[44:59], v[20:23], v[16:19], 0
    v_exp_f32 v76, v76
    v_exp_f32 v77, v77
    v_exp_f32 v78, v78
    v_exp_f32 v79, v79
    v_exp_f32 v80, v80
    v_smfmac_f32_32x32x32_bf16 v[108:123], v[36:39], v[60:67], v127
    s_setprio 1
    v_exp_f32 v81, v81
    v_exp_f32 v82, v82
    v_exp_f32 v83, v83
    v_exp_f32 v84, v84
    v_exp_f32 v85, v85
    v_smfmac_f32_32x32x32_bf16 v[108:123], v[40:43], v[68:75], v127
    s_setprio 0
    s_waitcnt lgkmcnt(0)
    v_exp_f32 v86, v86
    v_exp_f32 v87, v87
    v_exp_f32 v88, v88
    v_exp_f32 v89, v89
    v_exp_f32 v90, v90
    v_exp_f32 v91, v91
    s_waitcnt vmcnt(6)
    s_cmp_eq_u32 s99, 7
    s_cbranch_scc1 mega_kernel_fwc
mega_kernel_fwcd:
    s_cmp_eq_u32 s14, 0
    s_barrier
    s_cbranch_scc1 mega_kernel_fwv
mega_kernel_fwvd:
    v_mfma_f32_32x32x16_bf16 v[60:75], v[24:27], v[12:15], 0
    s_setprio 3
    v_add_u32 v8, 0x4000, v8
    ds_read_b128 v[20:23], v8 offset:0
    ds_read_b128 v[36:39], v9 offset:3072
    ds_read_b128 v[40:43], v9 offset:3584
    v_exp_f32 v44, v44
    v_exp_f32 v45, v45
    v_exp_f32 v46, v46
    v_exp_f32 v47, v47
    v_exp_f32 v48, v48
    v_smfmac_f32_32x32x32_bf16 v[92:107], v[28:31], v[76:83], v127
    v_exp_f32 v49, v49
    v_exp_f32 v50, v50
    v_exp_f32 v51, v51
    v_exp_f32 v52, v52
    v_exp_f32 v53, v53
    v_smfmac_f32_32x32x32_bf16 v[92:107], v[32:35], v[84:91], v127
    v_exp_f32 v54, v54
    v_exp_f32 v55, v55
    v_exp_f32 v56, v56
    v_exp_f32 v57, v57
    v_exp_f32 v58, v58
    v_exp_f32 v59, v59
    v_mfma_f32_32x32x16_bf16 v[76:91], v[24:27], v[16:19], 0
    v_exp_f32 v60, v60
    v_exp_f32 v61, v61
    v_exp_f32 v62, v62
    v_exp_f32 v63, v63
    v_exp_f32 v64, v64
    v_smfmac_f32_32x32x32_bf16 v[108:123], v[28:31], v[44:51], v127
    s_lshl_b32 s36, s3, 11
    s_add_u32 m0, s36, 0
    v_exp_f32 v65, v65
    v_exp_f32 v66, v66
    v_exp_f32 v67, v67
    v_exp_f32 v68, v68
    v_exp_f32 v69, v69
    v_smfmac_f32_32x32x32_bf16 v[108:123], v[32:35], v[52:59], v127
    s_waitcnt lgkmcnt(0)
    buffer_load_dwordx4 v125, s[4:7], m0 offen offset:0 lds
    v_exp_f32 v70, v70
    v_exp_f32 v71, v71
    v_exp_f32 v72, v72
    v_exp_f32 v73, v73
    v_exp_f32 v74, v74
    v_exp_f32 v75, v75
    v_mfma_f32_32x32x16_bf16 v[44:59], v[20:23], v[12:15], 0
    ds_read_b128 v[24:27], v8 offset:1024
    v_add_u32 v9, v10, v9
    ds_read_b128 v[28:31], v9 offset:0
    ds_read_b128 v[32:35], v9 offset:512
    v_exp_f32 v76, v76
    v_exp_f32 v77, v77
    v_exp_f32 v78, v78
    v_exp_f32 v79, v79
    v_exp_f32 v80, v80
    v_smfmac_f32_32x32x32_bf16 v[92:107], v[36:39], v[60:67], v127
    v_exp_f32 v81, v81
    v_exp_f32 v82, v82
    v_exp_f32 v83, v83
    v_exp_f32 v84, v84
    v_exp_f32 v85, v85
    v_smfmac_f32_32x32x32_bf16 v[92:107], v[40:43], v[68:75], v127
    buffer_load_dwordx4 v125, s[4:7], m0 offen offset:1024 lds
    v_exp_f32 v86, v86
    v_exp_f32 v87, v87
    v_exp_f32 v88, v88
    v_exp_f32 v89, v89
    v_exp_f32 v90, v90
    v_exp_f32 v91, v91
    v_mfma_f32_32x32x16_bf16 v[60:75], v[20:23], v[16:19], 0
    v_exp_f32 v44, v44
    v_exp_f32 v45, v45
    v_exp_f32 v46, v46
    v_exp_f32 v47, v47
    v_exp_f32 v48, v48
    v_smfmac_f32_32x32x32_bf16 v[108:123], v[36:39], v[76:83], v127
    s_lshl_b32 s36, s3, 11
    s_add_u32 m0, s36, 16384
    v_exp_f32 v49, v49
    v_exp_f32 v50, v50
    v_exp_f32 v51, v51
    v_exp_f32 v52, v52
    v_exp_f32 v53, v53
    v_smfmac_f32_32x32x32_bf16 v[108:123], v[40:43], v[84:91], v127
    s_waitcnt lgkmcnt(0)
    buffer_load_dwordx4 v125, s[4:7], m0 offen offset:0 lds
    v_exp_f32 v54, v54
    v_exp_f32 v55, v55
    v_exp_f32 v56, v56
    v_exp_f32 v57, v57
    v_exp_f32 v58, v58
    v_exp_f32 v59, v59
    v_mfma_f32_32x32x16_bf16 v[76:91], v[24:27], v[12:15], 0
    ds_read_b128 v[20:23], v8 offset:2048
    ds_read_b128 v[36:39], v9 offset:1024
    ds_read_b128 v[40:43], v9 offset:1536
    v_exp_f32 v60, v60
    v_exp_f32 v61, v61
    v_exp_f32 v62, v62
    v_exp_f32 v63, v63
    v_exp_f32 v64, v64
    v_smfmac_f32_32x32x32_bf16 v[92:107], v[28:31], v[44:51], v127
    v_exp_f32 v65, v65
    v_exp_f32 v66, v66
    v_exp_f32 v67, v67
    v_exp_f32 v68, v68
    v_exp_f32 v69, v69
    v_smfmac_f32_32x32x32_bf16 v[92:107], v[32:35], v[52:59], v127
    buffer_load_dwordx4 v125, s[4:7], m0 offen offset:1024 lds
    v_exp_f32 v70, v70
    v_exp_f32 v71, v71
    v_exp_f32 v72, v72
    v_exp_f32 v73, v73
    v_exp_f32 v74, v74
    v_exp_f32 v75, v75
    v_mfma_f32_32x32x16_bf16 v[44:59], v[24:27], v[16:19], 0
    v_exp_f32 v76, v76
    v_exp_f32 v77, v77
    v_exp_f32 v78, v78
    v_exp_f32 v79, v79
    v_exp_f32 v80, v80
    v_smfmac_f32_32x32x32_bf16 v[108:123], v[28:31], v[60:67], v127
    s_lshl_b32 s36, s3, 11
    s_add_u32 m0, s36, 32768
    v_exp_f32 v81, v81
    v_exp_f32 v82, v82
    v_exp_f32 v83, v83
    v_exp_f32 v84, v84
    v_exp_f32 v85, v85
    v_smfmac_f32_32x32x32_bf16 v[108:123], v[32:35], v[68:75], v127
    s_waitcnt lgkmcnt(0)
    buffer_load_dwordx4 v125, s[4:7], m0 offen offset:0 lds
    v_exp_f32 v86, v86
    v_exp_f32 v87, v87
    v_exp_f32 v88, v88
    v_exp_f32 v89, v89
    v_exp_f32 v90, v90
    v_exp_f32 v91, v91
    v_mfma_f32_32x32x16_bf16 v[60:75], v[20:23], v[12:15], 0
    ds_read_b128 v[24:27], v8 offset:3072
    ds_read_b128 v[28:31], v9 offset:2048
    ds_read_b128 v[32:35], v9 offset:2560
    v_exp_f32 v44, v44
    v_exp_f32 v45, v45
    v_exp_f32 v46, v46
    v_exp_f32 v47, v47
    v_exp_f32 v48, v48
    v_smfmac_f32_32x32x32_bf16 v[92:107], v[36:39], v[76:83], v127
    s_setprio 2
    v_exp_f32 v49, v49
    v_exp_f32 v50, v50
    v_exp_f32 v51, v51
    v_exp_f32 v52, v52
    v_exp_f32 v53, v53
    v_smfmac_f32_32x32x32_bf16 v[92:107], v[40:43], v[84:91], v127
    buffer_load_dwordx4 v125, s[4:7], m0 offen offset:1024 lds
    v_exp_f32 v54, v54
    v_exp_f32 v55, v55
    v_exp_f32 v56, v56
    v_exp_f32 v57, v57
    v_exp_f32 v58, v58
    v_exp_f32 v59, v59
    v_mfma_f32_32x32x16_bf16 v[76:91], v[20:23], v[16:19], 0
    v_exp_f32 v60, v60
    v_exp_f32 v61, v61
    v_exp_f32 v62, v62
    v_exp_f32 v63, v63
    v_exp_f32 v64, v64
    v_smfmac_f32_32x32x32_bf16 v[108:123], v[36:39], v[44:51], v127
    s_setprio 1
    v_exp_f32 v65, v65
    v_exp_f32 v66, v66
    v_exp_f32 v67, v67
    v_exp_f32 v68, v68
    v_exp_f32 v69, v69
    v_smfmac_f32_32x32x32_bf16 v[108:123], v[40:43], v[52:59], v127
    s_setprio 0
    s_waitcnt lgkmcnt(0)
    buffer_load_dwordx4 v[128:131], v2, s[4:7], s44 offen
    s_add_u32 s44, s44, s46
    buffer_load_dwordx4 v[132:135], v2, s[4:7], s45 offen
    s_add_u32 s45, s45, s46
    v_exp_f32 v70, v70
    v_exp_f32 v71, v71
    v_exp_f32 v72, v72
    v_exp_f32 v73, v73
    v_exp_f32 v74, v74
    v_exp_f32 v75, v75
    s_waitcnt vmcnt(12)
    s_barrier
    v_mfma_f32_32x32x16_bf16 v[44:59], v[24:27], v[12:15], 0
    s_setprio 3
    v_add_u32 v8, 0x4000, v8
    ds_read_b128 v[20:23], v8 offset:0
    ds_read_b128 v[36:39], v9 offset:3072
    ds_read_b128 v[40:43], v9 offset:3584
    v_exp_f32 v76, v76
    v_exp_f32 v77, v77
    v_exp_f32 v78, v78
    v_exp_f32 v79, v79
    v_exp_f32 v80, v80
    v_smfmac_f32_32x32x32_bf16 v[92:107], v[28:31], v[60:67], v127
    v_exp_f32 v81, v81
    v_exp_f32 v82, v82
    v_exp_f32 v83, v83
    v_exp_f32 v84, v84
    v_exp_f32 v85, v85
    v_smfmac_f32_32x32x32_bf16 v[92:107], v[32:35], v[68:75], v127
    buffer_load_dwordx4 v[136:139], v2, s[4:7], s44 offen
    s_add_u32 s44, s44, s46
    v_exp_f32 v86, v86
    v_exp_f32 v87, v87
    v_exp_f32 v88, v88
    v_exp_f32 v89, v89
    v_exp_f32 v90, v90
    v_exp_f32 v91, v91
    v_mfma_f32_32x32x16_bf16 v[60:75], v[24:27], v[16:19], 0
    v_exp_f32 v44, v44
    v_exp_f32 v45, v45
    v_exp_f32 v46, v46
    v_exp_f32 v47, v47
    v_exp_f32 v48, v48
    v_smfmac_f32_32x32x32_bf16 v[108:123], v[28:31], v[76:83], v127
    s_lshl_b32 s36, s3, 11
    s_add_u32 m0, s36, 49152
    v_exp_f32 v49, v49
    v_exp_f32 v50, v50
    v_exp_f32 v51, v51
    v_exp_f32 v52, v52
    v_exp_f32 v53, v53
    v_smfmac_f32_32x32x32_bf16 v[108:123], v[32:35], v[84:91], v127
    s_waitcnt lgkmcnt(0)
    buffer_load_dwordx4 v125, s[4:7], m0 offen offset:0 lds
    v_exp_f32 v54, v54
    v_exp_f32 v55, v55
    v_exp_f32 v56, v56
    v_exp_f32 v57, v57
    v_exp_f32 v58, v58
    v_exp_f32 v59, v59
    v_mfma_f32_32x32x16_bf16 v[76:91], v[20:23], v[12:15], 0
    ds_read_b128 v[24:27], v8 offset:1024
    v_add_u32 v9, v10, v9
    ds_read_b128 v[28:31], v9 offset:0
    ds_read_b128 v[32:35], v9 offset:512
    v_exp_f32 v60, v60
    v_exp_f32 v61, v61
    v_exp_f32 v62, v62
    v_exp_f32 v63, v63
    v_exp_f32 v64, v64
    v_smfmac_f32_32x32x32_bf16 v[92:107], v[36:39], v[44:51], v127
    v_exp_f32 v65, v65
    v_exp_f32 v66, v66
    v_exp_f32 v67, v67
    v_exp_f32 v68, v68
    v_exp_f32 v69, v69
    v_smfmac_f32_32x32x32_bf16 v[92:107], v[40:43], v[52:59], v127
    buffer_load_dwordx4 v125, s[4:7], m0 offen offset:1024 lds
    v_exp_f32 v70, v70
    v_exp_f32 v71, v71
    v_exp_f32 v72, v72
    v_exp_f32 v73, v73
    v_exp_f32 v74, v74
    v_exp_f32 v75, v75
    v_mfma_f32_32x32x16_bf16 v[44:59], v[20:23], v[16:19], 0
    v_exp_f32 v76, v76
    v_exp_f32 v77, v77
    v_exp_f32 v78, v78
    v_exp_f32 v79, v79
    v_exp_f32 v80, v80
    v_smfmac_f32_32x32x32_bf16 v[108:123], v[36:39], v[60:67], v127
    v_exp_f32 v81, v81
    v_exp_f32 v82, v82
    v_exp_f32 v83, v83
    v_exp_f32 v84, v84
    v_exp_f32 v85, v85
    v_smfmac_f32_32x32x32_bf16 v[108:123], v[40:43], v[68:75], v127
    s_waitcnt lgkmcnt(0)
    buffer_load_dwordx4 v[140:143], v2, s[4:7], s45 offen
    s_add_u32 s45, s45, s46
    buffer_load_dwordx4 v[144:147], v2, s[4:7], s44 offen
    s_add_u32 s44, s44, s46
    v_exp_f32 v86, v86
    v_exp_f32 v87, v87
    v_exp_f32 v88, v88
    v_exp_f32 v89, v89
    v_exp_f32 v90, v90
    v_exp_f32 v91, v91
    v_mfma_f32_32x32x16_bf16 v[60:75], v[24:27], v[12:15], 0
    ds_read_b128 v[20:23], v8 offset:2048
    ds_read_b128 v[36:39], v9 offset:1024
    ds_read_b128 v[40:43], v9 offset:1536
    v_exp_f32 v44, v44
    v_exp_f32 v45, v45
    v_exp_f32 v46, v46
    v_exp_f32 v47, v47
    v_exp_f32 v48, v48
    v_smfmac_f32_32x32x32_bf16 v[92:107], v[28:31], v[76:83], v127
    v_exp_f32 v49, v49
    v_exp_f32 v50, v50
    v_exp_f32 v51, v51
    v_exp_f32 v52, v52
    v_exp_f32 v53, v53
    v_smfmac_f32_32x32x32_bf16 v[92:107], v[32:35], v[84:91], v127
    buffer_load_dwordx4 v[148:151], v2, s[4:7], s45 offen
    s_add_u32 s45, s45, s46
    v_exp_f32 v54, v54
    v_exp_f32 v55, v55
    v_exp_f32 v56, v56
    v_exp_f32 v57, v57
    v_exp_f32 v58, v58
    v_exp_f32 v59, v59
    v_mfma_f32_32x32x16_bf16 v[76:91], v[24:27], v[16:19], 0
    v_exp_f32 v60, v60
    v_exp_f32 v61, v61
    v_exp_f32 v62, v62
    v_exp_f32 v63, v63
    v_exp_f32 v64, v64
    v_smfmac_f32_32x32x32_bf16 v[108:123], v[28:31], v[44:51], v127
    v_exp_f32 v65, v65
    v_exp_f32 v66, v66
    v_exp_f32 v67, v67
    v_exp_f32 v68, v68
    v_exp_f32 v69, v69
    v_smfmac_f32_32x32x32_bf16 v[108:123], v[32:35], v[52:59], v127
    s_waitcnt lgkmcnt(0)
    buffer_load_dwordx4 v[152:155], v2, s[4:7], s44 offen
    s_add_u32 s44, s44, s48
    buffer_load_dwordx4 v[156:159], v2, s[4:7], s45 offen
    s_add_u32 s45, s45, s48
    v_exp_f32 v70, v70
    v_exp_f32 v71, v71
    v_exp_f32 v72, v72
    v_exp_f32 v73, v73
    v_exp_f32 v74, v74
    v_exp_f32 v75, v75
    v_mfma_f32_32x32x16_bf16 v[44:59], v[20:23], v[12:15], 0
    ds_read_b128 v[24:27], v8 offset:3072
    ds_read_b128 v[28:31], v9 offset:2048
    ds_read_b128 v[32:35], v9 offset:2560
    v_exp_f32 v76, v76
    v_exp_f32 v77, v77
    v_exp_f32 v78, v78
    v_exp_f32 v79, v79
    v_exp_f32 v80, v80
    v_smfmac_f32_32x32x32_bf16 v[92:107], v[36:39], v[60:67], v127
    s_setprio 2
    v_exp_f32 v81, v81
    v_exp_f32 v82, v82
    v_exp_f32 v83, v83
    v_exp_f32 v84, v84
    v_exp_f32 v85, v85
    v_smfmac_f32_32x32x32_bf16 v[92:107], v[40:43], v[68:75], v127
    buffer_load_dwordx4 v[160:163], v2, s[4:7], s44 offen
    s_add_u32 s44, s44, s46
    v_exp_f32 v86, v86
    v_exp_f32 v87, v87
    v_exp_f32 v88, v88
    v_exp_f32 v89, v89
    v_exp_f32 v90, v90
    v_exp_f32 v91, v91
    v_mfma_f32_32x32x16_bf16 v[60:75], v[20:23], v[16:19], 0
    v_exp_f32 v44, v44
    v_exp_f32 v45, v45
    v_exp_f32 v46, v46
    v_exp_f32 v47, v47
    v_exp_f32 v48, v48
    v_smfmac_f32_32x32x32_bf16 v[108:123], v[36:39], v[76:83], v127
    s_setprio 1
    v_exp_f32 v49, v49
    v_exp_f32 v50, v50
    v_exp_f32 v51, v51
    v_exp_f32 v52, v52
    v_exp_f32 v53, v53
    v_smfmac_f32_32x32x32_bf16 v[108:123], v[40:43], v[84:91], v127
    s_setprio 0
    s_waitcnt lgkmcnt(0)
    buffer_load_dwordx4 v[164:167], v2, s[4:7], s45 offen
    s_add_u32 s45, s45, s46
    buffer_load_dwordx4 v[168:171], v2, s[4:7], s44 offen
    s_add_u32 s44, s44, s46
    v_exp_f32 v54, v54
    v_exp_f32 v55, v55
    v_exp_f32 v56, v56
    v_exp_f32 v57, v57
    v_exp_f32 v58, v58
    v_exp_f32 v59, v59
    s_waitcnt vmcnt(21)
    s_barrier
    v_mfma_f32_32x32x16_bf16 v[76:91], v[24:27], v[12:15], 0
    s_setprio 3
    v_add_u32 v8, 0x4000, v8
    ds_read_b128 v[20:23], v8 offset:0
    ds_read_b128 v[36:39], v9 offset:3072
    ds_read_b128 v[40:43], v9 offset:3584
    v_exp_f32 v60, v60
    v_exp_f32 v61, v61
    v_exp_f32 v62, v62
    v_exp_f32 v63, v63
    v_exp_f32 v64, v64
    v_smfmac_f32_32x32x32_bf16 v[92:107], v[28:31], v[44:51], v127
    v_exp_f32 v65, v65
    v_exp_f32 v66, v66
    v_exp_f32 v67, v67
    v_exp_f32 v68, v68
    v_exp_f32 v69, v69
    v_smfmac_f32_32x32x32_bf16 v[92:107], v[32:35], v[52:59], v127
    buffer_load_dwordx4 v[172:175], v2, s[4:7], s45 offen
    s_add_u32 s45, s45, s46
    v_exp_f32 v70, v70
    v_exp_f32 v71, v71
    v_exp_f32 v72, v72
    v_exp_f32 v73, v73
    v_exp_f32 v74, v74
    v_exp_f32 v75, v75
    v_mfma_f32_32x32x16_bf16 v[44:59], v[24:27], v[16:19], 0
    v_exp_f32 v76, v76
    v_exp_f32 v77, v77
    v_exp_f32 v78, v78
    v_exp_f32 v79, v79
    v_exp_f32 v80, v80
    v_smfmac_f32_32x32x32_bf16 v[108:123], v[28:31], v[60:67], v127
    s_lshl_b32 s36, s3, 11
    s_add_u32 m0, s36, 65536
    v_exp_f32 v81, v81
    v_exp_f32 v82, v82
    v_exp_f32 v83, v83
    v_exp_f32 v84, v84
    v_exp_f32 v85, v85
    v_smfmac_f32_32x32x32_bf16 v[108:123], v[32:35], v[68:75], v127
    s_waitcnt lgkmcnt(0)
    buffer_load_dwordx4 v125, s[4:7], m0 offen offset:0 lds
    v_exp_f32 v86, v86
    v_exp_f32 v87, v87
    v_exp_f32 v88, v88
    v_exp_f32 v89, v89
    v_exp_f32 v90, v90
    v_exp_f32 v91, v91
    v_mfma_f32_32x32x16_bf16 v[60:75], v[20:23], v[12:15], 0
    ds_read_b128 v[24:27], v8 offset:1024
    v_add_u32 v9, v10, v9
    ds_read_b128 v[28:31], v9 offset:0
    ds_read_b128 v[32:35], v9 offset:512
    v_exp_f32 v44, v44
    v_exp_f32 v45, v45
    v_exp_f32 v46, v46
    v_exp_f32 v47, v47
    v_exp_f32 v48, v48
    v_smfmac_f32_32x32x32_bf16 v[92:107], v[36:39], v[76:83], v127
    v_exp_f32 v49, v49
    v_exp_f32 v50, v50
    v_exp_f32 v51, v51
    v_exp_f32 v52, v52
    v_exp_f32 v53, v53
    v_smfmac_f32_32x32x32_bf16 v[92:107], v[40:43], v[84:91], v127
    buffer_load_dwordx4 v125, s[4:7], m0 offen offset:1024 lds
    v_exp_f32 v54, v54
    v_exp_f32 v55, v55
    v_exp_f32 v56, v56
    v_exp_f32 v57, v57
    v_exp_f32 v58, v58
    v_exp_f32 v59, v59
    buffer_load_dword v126, v1, s[56:59], s50 offen sc1
    v_mfma_f32_32x32x16_bf16 v[76:91], v[20:23], v[16:19], 0
    v_exp_f32 v60, v60
    v_exp_f32 v61, v61
    v_exp_f32 v62, v62
    v_exp_f32 v63, v63
    v_exp_f32 v64, v64
    v_smfmac_f32_32x32x32_bf16 v[108:123], v[36:39], v[44:51], v127
    v_exp_f32 v65, v65
    v_exp_f32 v66, v66
    v_exp_f32 v67, v67
    v_exp_f32 v68, v68
    v_exp_f32 v69, v69
    v_smfmac_f32_32x32x32_bf16 v[108:123], v[40:43], v[52:59], v127
    s_waitcnt lgkmcnt(0)
    buffer_load_dwordx4 v[176:179], v2, s[4:7], s44 offen
    s_add_u32 s44, s44, s46
    buffer_load_dwordx4 v[180:183], v2, s[4:7], s45 offen
    s_add_u32 s45, s45, s46
    v_exp_f32 v70, v70
    v_exp_f32 v71, v71
    v_exp_f32 v72, v72
    v_exp_f32 v73, v73
    v_exp_f32 v74, v74
    v_exp_f32 v75, v75
    v_mfma_f32_32x32x16_bf16 v[44:59], v[24:27], v[12:15], 0
    ds_read_b128 v[20:23], v8 offset:2048
    ds_read_b128 v[36:39], v9 offset:1024
    ds_read_b128 v[40:43], v9 offset:1536
    v_exp_f32 v76, v76
    v_exp_f32 v77, v77
    v_exp_f32 v78, v78
    v_exp_f32 v79, v79
    v_exp_f32 v80, v80
    v_smfmac_f32_32x32x32_bf16 v[92:107], v[28:31], v[60:67], v127
    v_exp_f32 v81, v81
    v_exp_f32 v82, v82
    v_exp_f32 v83, v83
    v_exp_f32 v84, v84
    v_exp_f32 v85, v85
    v_smfmac_f32_32x32x32_bf16 v[92:107], v[32:35], v[68:75], v127
    buffer_load_dwordx4 v[184:187], v2, s[4:7], s44 offen
    s_add_u32 s44, s44, s48
    v_exp_f32 v86, v86
    v_exp_f32 v87, v87
    v_exp_f32 v88, v88
    v_exp_f32 v89, v89
    v_exp_f32 v90, v90
    v_exp_f32 v91, v91
    buffer_load_dword v126, v11, s[56:59], s51 offen sc1
    v_mfma_f32_32x32x16_bf16 v[60:75], v[24:27], v[16:19], 0
    v_exp_f32 v44, v44
    v_exp_f32 v45, v45
    v_exp_f32 v46, v46
    v_exp_f32 v47, v47
    v_exp_f32 v48, v48
    v_smfmac_f32_32x32x32_bf16 v[108:123], v[28:31], v[76:83], v127
    v_exp_f32 v49, v49
    v_exp_f32 v50, v50
    v_exp_f32 v51, v51
    v_exp_f32 v52, v52
    v_exp_f32 v53, v53
    v_smfmac_f32_32x32x32_bf16 v[108:123], v[32:35], v[84:91], v127
    s_waitcnt lgkmcnt(0)
    buffer_load_dwordx4 v[188:191], v2, s[4:7], s45 offen
    s_add_u32 s45, s45, s48
    buffer_load_dwordx4 v[192:195], v2, s[4:7], s44 offen
    s_add_u32 s44, s44, s46
    v_exp_f32 v54, v54
    v_exp_f32 v55, v55
    v_exp_f32 v56, v56
    v_exp_f32 v57, v57
    v_exp_f32 v58, v58
    v_exp_f32 v59, v59
    v_mfma_f32_32x32x16_bf16 v[76:91], v[20:23], v[12:15], 0
    ds_read_b128 v[24:27], v8 offset:3072
    ds_read_b128 v[28:31], v9 offset:2048
    ds_read_b128 v[32:35], v9 offset:2560
    v_exp_f32 v60, v60
    v_exp_f32 v61, v61
    v_exp_f32 v62, v62
    v_exp_f32 v63, v63
    v_exp_f32 v64, v64
    v_smfmac_f32_32x32x32_bf16 v[92:107], v[36:39], v[44:51], v127
    s_setprio 2
    v_exp_f32 v65, v65
    v_exp_f32 v66, v66
    v_exp_f32 v67, v67
    v_exp_f32 v68, v68
    v_exp_f32 v69, v69
    v_smfmac_f32_32x32x32_bf16 v[92:107], v[40:43], v[52:59], v127
    buffer_load_dwordx4 v[196:199], v2, s[4:7], s45 offen
    s_add_u32 s45, s45, s46
    v_exp_f32 v70, v70
    v_exp_f32 v71, v71
    v_exp_f32 v72, v72
    v_exp_f32 v73, v73
    v_exp_f32 v74, v74
    v_exp_f32 v75, v75
    buffer_load_dword v126, v124, s[56:59], s52 offen sc1
    v_mfma_f32_32x32x16_bf16 v[44:59], v[20:23], v[16:19], 0
    v_exp_f32 v76, v76
    v_exp_f32 v77, v77
    v_exp_f32 v78, v78
    v_exp_f32 v79, v79
    v_exp_f32 v80, v80
    v_smfmac_f32_32x32x32_bf16 v[108:123], v[36:39], v[60:67], v127
    s_setprio 1
    v_exp_f32 v81, v81
    v_exp_f32 v82, v82
    v_exp_f32 v83, v83
    v_exp_f32 v84, v84
    v_exp_f32 v85, v85
    v_smfmac_f32_32x32x32_bf16 v[108:123], v[40:43], v[68:75], v127
    s_setprio 0
    s_waitcnt lgkmcnt(0)
    buffer_load_dwordx4 v[200:203], v2, s[4:7], s44 offen
    s_add_u32 s44, s44, s46
    buffer_load_dwordx4 v[204:207], v2, s[4:7], s45 offen
    s_add_u32 s45, s45, s46
    v_exp_f32 v86, v86
    v_exp_f32 v87, v87
    v_exp_f32 v88, v88
    v_exp_f32 v89, v89
    v_exp_f32 v90, v90
    v_exp_f32 v91, v91
    s_waitcnt vmcnt(33)
    s_barrier
    v_mfma_f32_32x32x16_bf16 v[60:75], v[24:27], v[12:15], 0
    s_setprio 3
    v_add_u32 v8, 0x4000, v8
    ds_read_b128 v[20:23], v8 offset:0
    ds_read_b128 v[36:39], v9 offset:3072
    ds_read_b128 v[40:43], v9 offset:3584
    v_exp_f32 v44, v44
    v_exp_f32 v45, v45
    v_exp_f32 v46, v46
    v_exp_f32 v47, v47
    v_exp_f32 v48, v48
    v_smfmac_f32_32x32x32_bf16 v[92:107], v[28:31], v[76:83], v127
    v_exp_f32 v49, v49
    v_exp_f32 v50, v50
    v_exp_f32 v51, v51
    v_exp_f32 v52, v52
    v_exp_f32 v53, v53
    v_smfmac_f32_32x32x32_bf16 v[92:107], v[32:35], v[84:91], v127
    buffer_load_dwordx4 v[208:211], v2, s[4:7], s44 offen
    s_add_u32 s44, s44, s46
    v_exp_f32 v54, v54
    v_exp_f32 v55, v55
    v_exp_f32 v56, v56
    v_exp_f32 v57, v57
    v_exp_f32 v58, v58
    v_exp_f32 v59, v59
    v_mfma_f32_32x32x16_bf16 v[76:91], v[24:27], v[16:19], 0
    v_exp_f32 v60, v60
    v_exp_f32 v61, v61
    v_exp_f32 v62, v62
    v_exp_f32 v63, v63
    v_exp_f32 v64, v64
    v_smfmac_f32_32x32x32_bf16 v[108:123], v[28:31], v[44:51], v127
    s_lshl_b32 s36, s3, 11
    s_add_u32 m0, s36, 81920
    v_exp_f32 v65, v65
    v_exp_f32 v66, v66
    v_exp_f32 v67, v67
    v_exp_f32 v68, v68
    v_exp_f32 v69, v69
    v_smfmac_f32_32x32x32_bf16 v[108:123], v[32:35], v[52:59], v127
    s_waitcnt lgkmcnt(0)
    buffer_load_dwordx4 v125, s[4:7], m0 offen offset:0 lds
    v_exp_f32 v70, v70
    v_exp_f32 v71, v71
    v_exp_f32 v72, v72
    v_exp_f32 v73, v73
    v_exp_f32 v74, v74
    v_exp_f32 v75, v75
    v_mfma_f32_32x32x16_bf16 v[44:59], v[20:23], v[12:15], 0
    ds_read_b128 v[24:27], v8 offset:1024
    v_add_u32 v9, v10, v9
    ds_read_b128 v[28:31], v9 offset:0
    ds_read_b128 v[32:35], v9 offset:512
    v_exp_f32 v76, v76
    v_exp_f32 v77, v77
    v_exp_f32 v78, v78
    v_exp_f32 v79, v79
    v_exp_f32 v80, v80
    v_smfmac_f32_32x32x32_bf16 v[92:107], v[36:39], v[60:67], v127
    v_exp_f32 v81, v81
    v_exp_f32 v82, v82
    v_exp_f32 v83, v83
    v_exp_f32 v84, v84
    v_exp_f32 v85, v85
    v_smfmac_f32_32x32x32_bf16 v[92:107], v[40:43], v[68:75], v127
    buffer_load_dwordx4 v125, s[4:7], m0 offen offset:1024 lds
    v_exp_f32 v86, v86
    v_exp_f32 v87, v87
    v_exp_f32 v88, v88
    v_exp_f32 v89, v89
    v_exp_f32 v90, v90
    v_exp_f32 v91, v91
    v_mfma_f32_32x32x16_bf16 v[60:75], v[20:23], v[16:19], 0
    v_exp_f32 v44, v44
    v_exp_f32 v45, v45
    v_exp_f32 v46, v46
    v_exp_f32 v47, v47
    v_exp_f32 v48, v48
    v_smfmac_f32_32x32x32_bf16 v[108:123], v[36:39], v[76:83], v127
    v_exp_f32 v49, v49
    v_exp_f32 v50, v50
    v_exp_f32 v51, v51
    v_exp_f32 v52, v52
    v_exp_f32 v53, v53
    v_smfmac_f32_32x32x32_bf16 v[108:123], v[40:43], v[84:91], v127
    s_waitcnt lgkmcnt(0)
    buffer_load_dwordx4 v[212:215], v2, s[4:7], s45 offen
    s_add_u32 s45, s45, s46
    buffer_load_dwordx4 v[216:219], v2, s[4:7], s44 offen
    s_add_u32 s44, s44, s48
    v_exp_f32 v54, v54
    v_exp_f32 v55, v55
    v_exp_f32 v56, v56
    v_exp_f32 v57, v57
    v_exp_f32 v58, v58
    v_exp_f32 v59, v59
    v_mfma_f32_32x32x16_bf16 v[76:91], v[24:27], v[12:15], 0
    ds_read_b128 v[20:23], v8 offset:2048
    ds_read_b128 v[36:39], v9 offset:1024
    ds_read_b128 v[40:43], v9 offset:1536
    v_exp_f32 v60, v60
    v_exp_f32 v61, v61
    v_exp_f32 v62, v62
    v_exp_f32 v63, v63
    v_exp_f32 v64, v64
    v_smfmac_f32_32x32x32_bf16 v[92:107], v[28:31], v[44:51], v127
    v_exp_f32 v65, v65
    v_exp_f32 v66, v66
    v_exp_f32 v67, v67
    v_exp_f32 v68, v68
    v_exp_f32 v69, v69
    v_smfmac_f32_32x32x32_bf16 v[92:107], v[32:35], v[52:59], v127
    buffer_load_dwordx4 v[220:223], v2, s[4:7], s45 offen
    s_add_u32 s45, s45, s48
    v_exp_f32 v70, v70
    v_exp_f32 v71, v71
    v_exp_f32 v72, v72
    v_exp_f32 v73, v73
    v_exp_f32 v74, v74
    v_exp_f32 v75, v75
    v_mfma_f32_32x32x16_bf16 v[44:59], v[24:27], v[16:19], 0
    v_exp_f32 v76, v76
    v_exp_f32 v77, v77
    v_exp_f32 v78, v78
    v_exp_f32 v79, v79
    v_exp_f32 v80, v80
    v_smfmac_f32_32x32x32_bf16 v[108:123], v[28:31], v[60:67], v127
    v_exp_f32 v81, v81
    v_exp_f32 v82, v82
    v_exp_f32 v83, v83
    v_exp_f32 v84, v84
    v_exp_f32 v85, v85
    v_smfmac_f32_32x32x32_bf16 v[108:123], v[32:35], v[68:75], v127
    s_waitcnt lgkmcnt(0)
    buffer_load_dwordx4 v[224:227], v2, s[4:7], s44 offen
    s_add_u32 s44, s44, s46
    buffer_load_dwordx4 v[228:231], v2, s[4:7], s45 offen
    s_add_u32 s45, s45, s46
    v_exp_f32 v86, v86
    v_exp_f32 v87, v87
    v_exp_f32 v88, v88
    v_exp_f32 v89, v89
    v_exp_f32 v90, v90
    v_exp_f32 v91, v91
    v_mfma_f32_32x32x16_bf16 v[60:75], v[20:23], v[12:15], 0
    ds_read_b128 v[24:27], v8 offset:3072
    ds_read_b128 v[28:31], v9 offset:2048
    ds_read_b128 v[32:35], v9 offset:2560
    v_exp_f32 v44, v44
    v_exp_f32 v45, v45
    v_exp_f32 v46, v46
    v_exp_f32 v47, v47
    v_exp_f32 v48, v48
    v_smfmac_f32_32x32x32_bf16 v[92:107], v[36:39], v[76:83], v127
    v_exp_f32 v49, v49
    v_exp_f32 v50, v50
    v_exp_f32 v51, v51
    v_exp_f32 v52, v52
    v_exp_f32 v53, v53
    v_smfmac_f32_32x32x32_bf16 v[92:107], v[40:43], v[84:91], v127
    buffer_load_dwordx4 v[232:235], v2, s[4:7], s44 offen
    s_add_u32 s44, s44, s46
    v_exp_f32 v54, v54
    v_exp_f32 v55, v55
    v_exp_f32 v56, v56
    v_exp_f32 v57, v57
    v_exp_f32 v58, v58
    v_exp_f32 v59, v59
    v_mfma_f32_32x32x16_bf16 v[76:91], v[20:23], v[16:19], 0
    v_exp_f32 v60, v60
    v_exp_f32 v61, v61
    v_exp_f32 v62, v62
    v_exp_f32 v63, v63
    v_exp_f32 v64, v64
    v_smfmac_f32_32x32x32_bf16 v[108:123], v[36:39], v[44:51], v127
    v_exp_f32 v65, v65
    v_exp_f32 v66, v66
    v_exp_f32 v67, v67
    v_exp_f32 v68, v68
    v_exp_f32 v69, v69
    v_smfmac_f32_32x32x32_bf16 v[108:123], v[40:43], v[52:59], v127
    s_waitcnt lgkmcnt(0)
    buffer_load_dwordx4 v[236:239], v2, s[4:7], s45 offen
    s_add_u32 s45, s45, s46
    buffer_load_dwordx4 v[240:243], v2, s[4:7], s44 offen
    s_add_u32 s44, s44, s46
    v_exp_f32 v70, v70
    v_exp_f32 v71, v71
    v_exp_f32 v72, v72
    v_exp_f32 v73, v73
    v_exp_f32 v74, v74
    v_exp_f32 v75, v75
    v_mfma_f32_32x32x16_bf16 v[44:59], v[24:27], v[12:15], 0
    ds_read_b128 v[36:39], v9 offset:3072
    ds_read_b128 v[40:43], v9 offset:3584
    v_exp_f32 v76, v76
    v_exp_f32 v77, v77
    v_exp_f32 v78, v78
    v_exp_f32 v79, v79
    v_exp_f32 v80, v80
    v_smfmac_f32_32x32x32_bf16 v[92:107], v[28:31], v[60:67], v127
    v_exp_f32 v81, v81
    v_exp_f32 v82, v82
    v_exp_f32 v83, v83
    v_exp_f32 v84, v84
    v_exp_f32 v85, v85
    v_smfmac_f32_32x32x32_bf16 v[92:107], v[32:35], v[68:75], v127
    s_setprio 2
    buffer_load_dwordx4 v[244:247], v2, s[4:7], s45 offen
    s_add_u32 s45, s45, s46
    v_exp_f32 v86, v86
    v_exp_f32 v87, v87
    v_exp_f32 v88, v88
    v_exp_f32 v89, v89
    v_exp_f32 v90, v90
    v_exp_f32 v91, v91
    v_mfma_f32_32x32x16_bf16 v[60:75], v[24:27], v[16:19], 0
    v_exp_f32 v44, v44
    v_exp_f32 v45, v45
    v_exp_f32 v46, v46
    v_exp_f32 v47, v47
    v_exp_f32 v48, v48
    v_smfmac_f32_32x32x32_bf16 v[108:123], v[28:31], v[76:83], v127
    v_exp_f32 v49, v49
    v_exp_f32 v50, v50
    v_exp_f32 v51, v51
    v_exp_f32 v52, v52
    v_exp_f32 v53, v53
    v_smfmac_f32_32x32x32_bf16 v[108:123], v[32:35], v[84:91], v127
    s_waitcnt lgkmcnt(0)
    buffer_load_dwordx4 v[248:251], v2, s[4:7], s44 offen
    s_add_u32 s44, s44, s48
    v_exp_f32 v54, v54
    v_exp_f32 v55, v55
    v_exp_f32 v56, v56
    v_exp_f32 v57, v57
    v_exp_f32 v58, v58
    v_exp_f32 v59, v59
    v_exp_f32 v60, v60
    v_exp_f32 v61, v61
    v_exp_f32 v62, v62
    v_exp_f32 v63, v63
    v_exp_f32 v64, v64
    v_smfmac_f32_32x32x32_bf16 v[92:107], v[36:39], v[44:51], v127
    s_setprio 1
    v_exp_f32 v65, v65
    v_exp_f32 v66, v66
    v_exp_f32 v67, v67
    v_exp_f32 v68, v68
    v_exp_f32 v69, v69
    v_smfmac_f32_32x32x32_bf16 v[92:107], v[40:43], v[52:59], v127
    s_setprio 0
    buffer_load_dwordx4 v[252:255], v2, s[4:7], s45 offen
    s_add_u32 s45, s45, s48
    v_exp_f32 v70, v70
    v_exp_f32 v71, v71
    v_exp_f32 v72, v72
    v_exp_f32 v73, v73
    v_exp_f32 v74, v74
    v_exp_f32 v75, v75
    v_smfmac_f32_32x32x32_bf16 v[108:123], v[36:39], v[60:67], v127
    s_nop 0
    v_smfmac_f32_32x32x32_bf16 v[108:123], v[40:43], v[68:75], v127
    s_setprio 0
    s_mul_i32 s36, s3, 2560
    s_add_u32 s36, s36, 131072
    v_add_u32 v8, s36, v1
    v_lshlrev_b32 v9, 2, v0
    v_add_u32 v10, s36, v9
    s_xor_b32 s37, s3, 4
    s_mul_i32 s37, s37, 2560
    s_add_u32 s37, s37, 131072
    v_add_u32 v11, s37, v1
    v_add_u32 v9, s37, v9
    s_lshl_b32 s39, s33, 7
    s_lshl_b32 s41, s13, 2
    s_add_u32 s39, s39, s41
    s_add_u32 s39, s39, 0x8000
    s_mov_b32 s41, 0x21800000
    s_and_b32 s54, s54, 0xfffff800
    v_lshrrev_b32 v124, 5, v0
    s_cmp_eq_u32 s14, 0
    s_cselect_b32 s42, 512, 8
    s_cselect_b64 vcc, -1, 0
    v_lshl_add_u32 v124, v124, 2, v5
    v_cndmask_b32 v124, v1, v124
    v_add_u32 v124, s54, v124
    v_add_u32 v20, s42, v124
    ds_write_b128 v8, v[108:111]
    ds_write_b128 v8, v[112:115] offset:1024
    ds_write_b32 v10, v116 offset:2048
    ds_read2_b64 v[80:83], v124 offset1:128
    ds_read2_b64 v[84:87], v20 offset1:128
    s_waitcnt lgkmcnt(2)
    s_barrier
    ds_read_b32 v116, v9 offset:2048
    ds_read_b128 v[108:111], v11
    ds_read_b128 v[112:115], v11 offset:1024
    s_waitcnt lgkmcnt(2)
    v_add_f32 v100, v100, v116
    v_cmp_gt_f32 vcc, 0x5d800000, v100
    v_cmp_lt_f32 s[36:37], s41, v100
    v_rcp_f32 v11, v100
    s_and_b64 s[36:37], s[36:37], vcc
    s_cmp_eq_u64 s[36:37], exec
    s_waitcnt lgkmcnt(0)
    s_cbranch_scc0 mega_kernel_a_fb
    v_add_f32 v92, v92, v108
    v_add_f32 v93, v93, v109
    v_add_f32 v94, v94, v110
    v_add_f32 v95, v95, v111
    v_add_f32 v96, v96, v112
    v_add_f32 v97, v97, v113
    v_add_f32 v98, v98, v114
    v_add_f32 v99, v99, v115
mega_kernel_a_out:
    v_mul_f32 v92, v11, v92
    v_mul_f32 v93, v11, v93
    v_mul_f32 v94, v11, v94
    v_mul_f32 v95, v11, v95
    v_mul_f32 v96, v11, v96
    v_mul_f32 v97, v11, v97
    v_mul_f32 v98, v11, v98
    v_mul_f32 v99, v11, v99
    v_cvt_pk_bf16_f32 v44, v92, v93
    v_cvt_pk_bf16_f32 v45, v94, v95
    v_cvt_pk_bf16_f32 v46, v96, v97
    v_cvt_pk_bf16_f32 v47, v98, v99
    buffer_store_dwordx4 v[44:47], v1, s[56:59], s50 offen
    v_mov_b32 v8, 1
    s_mov_b64 exec, 1
    s_cmp_lg_u32 s15, 0
    s_waitcnt vmcnt(0)
    s_cbranch_scc1 mega_kernel_sig15a
    buffer_store_dword v8, off, s[8:11], s39
mega_kernel_sig15b:
    s_mov_b64 exec, -1
    s_lshl_b32 s36, s3, 11
    s_add_u32 m0, s36, 98304
    v_bfe_u32 v8, v0, 2, 1
    v_and_b32 v9, 3, v0
    v_lshlrev_b32 v8, 7, v8
    v_lshl_add_u32 v8, v9, 5, v8
    s_lshl_b32 s36, s20, 7
    s_lshl_b32 s37, s3, 2
    s_add_u32 s36, s36, s37
    s_add_u32 s36, s36, 0x8000
    s_mul_i32 s37, s20, 114688
    s_lshl_b32 s38, s3, 10
    s_add_u32 s37, s37, s38
    s_add_u32 s37, s37, 0x240000
    s_add_u32 s38, s37, 113664
    s_lshr_b32 s39, s16, 1
    s_lshl_b32 s39, s39, 10
    s_add_u32 s39, s39, 98304
    v_add_u32 v10, s39, v1
    s_barrier
    s_mov_b32 s35, 0
mega_kernel_poll16:
    buffer_load_dword v9, v8, s[8:11], s36 offen sc1
    s_add_u32 s35, s35, 1
    s_cmp_gt_u32 s35, 20000
    s_cbranch_scc1 mega_kernel_end
    s_waitcnt vmcnt(0)
    v_cmp_ne_u32 vcc, 1, v9
    s_cbranch_vccnz mega_kernel_poll16
mega_kernel_poll16x:
    s_cmp_lg_u32 s15, 0
    s_cbranch_scc1 mega_kernel_poll16a
mega_kernel_poll16b:
    buffer_load_dwordx4 v1, s[56:59], s37 offen sc1 lds
    buffer_load_dwordx4 v1, s[56:59], s38 offen offset:1024 sc1 lds
    s_add_u32 m0, m0, 16384
    s_add_u32 s37, s37, 8192
    s_add_u32 s38, s38, 8192
    buffer_load_dwordx4 v1, s[56:59], s37 offen sc1 lds
    buffer_load_dwordx4 v1, s[56:59], s38 offen offset:1024 sc1 lds
    s_add_u32 m0, m0, 16384
    s_add_u32 s37, s37, 8192
    s_add_u32 s38, s38, 8192
    buffer_load_dwordx4 v1, s[56:59], s37 offen sc1 lds
    buffer_load_dwordx4 v1, s[56:59], s38 offen offset:1024 sc1 lds
    s_add_u32 m0, m0, 16384
    s_add_u32 s37, s37, 8192
    s_add_u32 s38, s38, 8192
    buffer_load_dwordx4 v1, s[56:59], s37 offen sc1 lds
    buffer_load_dwordx4 v1, s[56:59], s38 offen offset:1024 sc1 lds
    s_cmp_lg_u32 s17, 0
    s_cbranch_scc1 mega_kernel_wo_h
    v_lshlrev_b32 v64, 16, v80
    v_and_b32 v65, 0xffff0000, v80
    v_lshlrev_b32 v66, 16, v81
    v_and_b32 v67, 0xffff0000, v81
    v_lshlrev_b32 v68, 16, v84
    v_and_b32 v69, 0xffff0000, v84
    v_lshlrev_b32 v70, 16, v85
    v_and_b32 v71, 0xffff0000, v85
    v_lshlrev_b32 v72, 16, v82
    v_and_b32 v73, 0xffff0000, v82
    v_lshlrev_b32 v74, 16, v83
    v_and_b32 v75, 0xffff0000, v83
    v_lshlrev_b32 v76, 16, v86
    v_and_b32 v77, 0xffff0000, v86
    v_lshlrev_b32 v78, 16, v87
    v_and_b32 v79, 0xffff0000, v87
    s_waitcnt vmcnt(6)
    s_barrier
    ds_read_b128 v[32:35], v10 offset:0
    ds_read_b128 v[36:39], v10 offset:2048
    ds_read_b128 v[40:43], v10 offset:4096
    ds_read_b128 v[44:47], v10 offset:6144
    ds_read_b128 v[48:51], v10 offset:8192
    ds_read_b128 v[52:55], v10 offset:10240
    s_waitcnt lgkmcnt(5)
    v_mfma_f32_32x32x16_bf16 v[64:79], v[128:131], v[32:35], v[64:79]
    ds_read_b128 v[56:59], v10 offset:12288
    s_waitcnt lgkmcnt(5)
    v_mfma_f32_32x32x16_bf16 v[64:79], v[132:135], v[36:39], v[64:79]
    ds_read_b128 v[60:63], v10 offset:14336
    s_waitcnt lgkmcnt(5)
    v_mfma_f32_32x32x16_bf16 v[64:79], v[136:139], v[40:43], v[64:79]
    s_waitcnt vmcnt(4)
    s_barrier
    ds_read_b128 v[32:35], v10 offset:16384
    s_waitcnt lgkmcnt(5)
    v_mfma_f32_32x32x16_bf16 v[64:79], v[140:143], v[44:47], v[64:79]
    ds_read_b128 v[36:39], v10 offset:18432
    s_waitcnt lgkmcnt(5)
    v_mfma_f32_32x32x16_bf16 v[64:79], v[144:147], v[48:51], v[64:79]
    ds_read_b128 v[40:43], v10 offset:20480
    s_waitcnt lgkmcnt(5)
    v_mfma_f32_32x32x16_bf16 v[64:79], v[148:151], v[52:55], v[64:79]
    ds_read_b128 v[44:47], v10 offset:22528
    s_waitcnt lgkmcnt(5)
    v_mfma_f32_32x32x16_bf16 v[64:79], v[152:155], v[56:59], v[64:79]
    ds_read_b128 v[48:51], v10 offset:24576
    s_waitcnt lgkmcnt(5)
    v_mfma_f32_32x32x16_bf16 v[64:79], v[156:159], v[60:63], v[64:79]
    ds_read_b128 v[52:55], v10 offset:26624
    s_waitcnt lgkmcnt(5)
    v_mfma_f32_32x32x16_bf16 v[64:79], v[160:163], v[32:35], v[64:79]
    ds_read_b128 v[56:59], v10 offset:28672
    s_waitcnt lgkmcnt(5)
    v_mfma_f32_32x32x16_bf16 v[64:79], v[164:167], v[36:39], v[64:79]
    ds_read_b128 v[60:63], v10 offset:30720
    s_waitcnt lgkmcnt(5)
    v_mfma_f32_32x32x16_bf16 v[64:79], v[168:171], v[40:43], v[64:79]
    s_waitcnt vmcnt(2)
    s_barrier
    ds_read_b128 v[32:35], v10 offset:32768
    s_waitcnt lgkmcnt(5)
    v_mfma_f32_32x32x16_bf16 v[64:79], v[172:175], v[44:47], v[64:79]
    ds_read_b128 v[36:39], v10 offset:34816
    s_waitcnt lgkmcnt(5)
    v_mfma_f32_32x32x16_bf16 v[64:79], v[176:179], v[48:51], v[64:79]
    ds_read_b128 v[40:43], v10 offset:36864
    s_waitcnt lgkmcnt(5)
    v_mfma_f32_32x32x16_bf16 v[64:79], v[180:183], v[52:55], v[64:79]
    ds_read_b128 v[44:47], v10 offset:38912
    s_waitcnt lgkmcnt(5)
    v_mfma_f32_32x32x16_bf16 v[64:79], v[184:187], v[56:59], v[64:79]
    ds_read_b128 v[48:51], v10 offset:40960
    s_waitcnt lgkmcnt(5)
    v_mfma_f32_32x32x16_bf16 v[64:79], v[188:191], v[60:63], v[64:79]
    ds_read_b128 v[52:55], v10 offset:43008
    s_waitcnt lgkmcnt(5)
    v_mfma_f32_32x32x16_bf16 v[64:79], v[192:195], v[32:35], v[64:79]
    ds_read_b128 v[56:59], v10 offset:45056
    s_waitcnt lgkmcnt(5)
    v_mfma_f32_32x32x16_bf16 v[64:79], v[196:199], v[36:39], v[64:79]
    ds_read_b128 v[60:63], v10 offset:47104
    s_waitcnt lgkmcnt(5)
    v_mfma_f32_32x32x16_bf16 v[64:79], v[200:203], v[40:43], v[64:79]
    s_waitcnt vmcnt(0)
    s_barrier
    ds_read_b128 v[32:35], v10 offset:49152
    s_waitcnt lgkmcnt(5)
    v_mfma_f32_32x32x16_bf16 v[64:79], v[204:207], v[44:47], v[64:79]
    ds_read_b128 v[36:39], v10 offset:51200
    s_waitcnt lgkmcnt(5)
    v_mfma_f32_32x32x16_bf16 v[64:79], v[208:211], v[48:51], v[64:79]
    ds_read_b128 v[40:43], v10 offset:53248
    s_waitcnt lgkmcnt(5)
    v_mfma_f32_32x32x16_bf16 v[64:79], v[212:215], v[52:55], v[64:79]
    ds_read_b128 v[44:47], v10 offset:55296
    s_waitcnt lgkmcnt(5)
    v_mfma_f32_32x32x16_bf16 v[64:79], v[216:219], v[56:59], v[64:79]
    ds_read_b128 v[48:51], v10 offset:57344
    s_waitcnt lgkmcnt(5)
    v_mfma_f32_32x32x16_bf16 v[64:79], v[220:223], v[60:63], v[64:79]
    ds_read_b128 v[52:55], v10 offset:59392
    s_waitcnt lgkmcnt(5)
    v_mfma_f32_32x32x16_bf16 v[64:79], v[224:227], v[32:35], v[64:79]
    ds_read_b128 v[56:59], v10 offset:61440
    s_waitcnt lgkmcnt(5)
    v_mfma_f32_32x32x16_bf16 v[64:79], v[228:231], v[36:39], v[64:79]
    ds_read_b128 v[60:63], v10 offset:63488
    s_waitcnt lgkmcnt(5)
    v_mfma_f32_32x32x16_bf16 v[64:79], v[232:235], v[40:43], v[64:79]
    s_waitcnt lgkmcnt(4)
    v_mfma_f32_32x32x16_bf16 v[64:79], v[236:239], v[44:47], v[64:79]
    s_waitcnt lgkmcnt(3)
    v_mfma_f32_32x32x16_bf16 v[64:79], v[240:243], v[48:51], v[64:79]
    s_waitcnt lgkmcnt(2)
    v_mfma_f32_32x32x16_bf16 v[64:79], v[244:247], v[52:55], v[64:79]
    s_waitcnt lgkmcnt(1)
    v_mfma_f32_32x32x16_bf16 v[64:79], v[248:251], v[56:59], v[64:79]
    s_waitcnt lgkmcnt(0)
    v_mfma_f32_32x32x16_bf16 v[64:79], v[252:255], v[60:63], v[64:79]
    s_barrier
    s_add_u32 s36, s22, 0x0
    s_add_u32 s37, s23, 0x200000
    s_add_u32 s38, s32, 0xa000
    s_nop 7
    v_cvt_pk_bf16_f32 v64, v64, v65
    v_cvt_pk_bf16_f32 v65, v66, v67
    v_cvt_pk_bf16_f32 v66, v68, v69
    v_cvt_pk_bf16_f32 v67, v70, v71
    buffer_store_dwordx4 v[64:67], v1, s[56:59], s36 offen offset:0
    v_cvt_pk_bf16_f32 v72, v72, v73
    v_cvt_pk_bf16_f32 v73, v74, v75
    v_cvt_pk_bf16_f32 v74, v76, v77
    v_cvt_pk_bf16_f32 v75, v78, v79
    buffer_store_dwordx4 v[72:75], v1, s[56:59], s36 offen offset:1024
    v_dot2_f32_bf16 v8, v64, v6, 0
    v_dot2_f32_bf16 v9, v64, v64, 0
    v_dot2_f32_bf16 v8, v65, v6, v8
    v_dot2_f32_bf16 v9, v65, v65, v9
    v_dot2_f32_bf16 v8, v66, v6, v8
    v_dot2_f32_bf16 v9, v66, v66, v9
    v_dot2_f32_bf16 v8, v67, v6, v8
    v_dot2_f32_bf16 v9, v67, v67, v9
    v_dot2_f32_bf16 v8, v72, v6, v8
    v_dot2_f32_bf16 v9, v72, v72, v9
    v_dot2_f32_bf16 v8, v73, v6, v8
    v_dot2_f32_bf16 v9, v73, v73, v9
    v_dot2_f32_bf16 v8, v74, v6, v8
    v_dot2_f32_bf16 v9, v74, v74, v9
    v_dot2_f32_bf16 v8, v75, v6, v8
    v_dot2_f32_bf16 v9, v75, v75, v9
    s_nop 2
    v_permlane32_swap_b32 v8, v9
    v_add_f32 v8, v8, v9
    buffer_store_dword v8, v5, s[56:59], s37 offen
    v_mov_b32 v10, 1
    s_mov_b64 exec, 1
    s_cmp_lg_u32 s15, 0
    s_waitcnt vmcnt(0)
    s_cbranch_scc1 mega_kernel_sig17a
    buffer_store_dword v10, off, s[8:11], s38
mega_kernel_sig17b:
    s_mov_b64 exec, -1
    s_mul_i32 s40, s18, 114688
    s_mul_i32 s41, s19, 7168
    s_add_u32 s40, s40, s41
    s_add_u32 s40, s40, 0x240000
    s_add_u32 s41, s40, 4096
    s_lshl_b32 s43, s18, 7
    s_lshl_b32 s36, s19, 2
    s_add_u32 s43, s43, s36
    s_add_u32 s43, s43, 0xc000
    s_cmp_lg_u32 s15, 0
    s_cselect_b32 s42, 0x80000000, 0
    s_lshl_b32 s36, s18, 7
    s_add_u32 s36, s36, 0xa000
    v_and_b32 v8, 15, v0
    v_lshlrev_b32 v8, 2, v8
    s_lshl_b32 s37, s18, 12
    s_add_u32 s37, s37, 0x200000
    s_lshl_b32 s38, s18, 15
    s_add_u32 s38, s38, 0x0
    s_mov_b32 s35, 0
mega_kernel_poll18:
    buffer_load_dword v9, v8, s[8:11], s36 offen sc1
    s_add_u32 s35, s35, 1
    s_cmp_gt_u32 s35, 20000
    s_cbranch_scc1 mega_kernel_end
    s_waitcnt vmcnt(0)
    v_cmp_ne_u32 vcc, 1, v9
    s_cbranch_vccnz mega_kernel_poll18
mega_kernel_poll18x:
    s_cmp_lg_u32 s15, 0
    s_cbranch_scc1 mega_kernel_poll18a
mega_kernel_poll18b:
    buffer_load_dwordx4 v[128:131], v1, s[56:59], s38 offen offset:0 sc1
    buffer_load_dwordx4 v[132:135], v1, s[56:59], s38 offen offset:1024 sc1
    buffer_load_dwordx4 v[136:139], v1, s[56:59], s38 offen offset:2048 sc1
    buffer_load_dwordx4 v[140:143], v1, s[56:59], s38 offen offset:3072 sc1
    s_add_u32 s38, s38, 4096
    buffer_load_dwordx4 v[144:147], v1, s[56:59], s38 offen offset:0 sc1
    buffer_load_dwordx4 v[148:151], v1, s[56:59], s38 offen offset:1024 sc1
    buffer_load_dwordx4 v[8:11], v4, s[56:59], s37 offen offset:0 sc1
    buffer_load_dwordx4 v[12:15], v4, s[56:59], s37 offen offset:512 sc1
    buffer_load_dwordx4 v[16:19], v4, s[56:59], s37 offen offset:1024 sc1
    buffer_load_dwordx4 v[20:23], v4, s[56:59], s37 offen offset:1536 sc1
    buffer_load_dwordx4 v[152:155], v1, s[56:59], s38 offen offset:2048 sc1
    buffer_load_dwordx4 v[156:159], v1, s[56:59], s38 offen offset:3072 sc1
    s_add_u32 s38, s38, 4096
    buffer_load_dwordx4 v[160:163], v1, s[56:59], s38 offen offset:0 sc1
    buffer_load_dwordx4 v[164:167], v1, s[56:59], s38 offen offset:1024 sc1
    buffer_load_dwordx4 v[168:171], v1, s[56:59], s38 offen offset:2048 sc1
    buffer_load_dwordx4 v[172:175], v1, s[56:59], s38 offen offset:3072 sc1
    s_add_u32 s38, s38, 4096
    ds_read_b128 v[32:35], v2 offset:0
    ds_read_b128 v[36:39], v2 offset:1024
    ds_read_b128 v[40:43], v2 offset:2048
    ds_read_b128 v[44:47], v2 offset:3072
    ds_read_b128 v[48:51], v2 offset:4096
    ds_read_b128 v[52:55], v2 offset:5120
    ds_read_b128 v[56:59], v2 offset:6144
    s_waitcnt vmcnt(15) lgkmcnt(6)
    v_mfma_f32_32x32x16_bf16 v[64:79], v[32:35], v[128:131], 0
    buffer_load_dwordx4 v[176:179], v1, s[56:59], s38 offen offset:0 sc1
    ds_read_b128 v[60:63], v2 offset:7168
    s_waitcnt lgkmcnt(6)
    v_mfma_f32_32x32x16_bf16 v[80:95], v[36:39], v[128:131], 0
    ds_read_b128 v[32:35], v2 offset:8192
    s_waitcnt lgkmcnt(6)
    v_mfma_f32_32x32x16_bf16 v[96:111], v[40:43], v[128:131], 0
    ds_read_b128 v[36:39], v2 offset:9216
    s_waitcnt vmcnt(15) lgkmcnt(6)
    v_mfma_f32_32x32x16_bf16 v[64:79], v[44:47], v[132:135], v[64:79]
    buffer_load_dwordx4 v[180:183], v1, s[56:59], s38 offen offset:1024 sc1
    ds_read_b128 v[40:43], v2 offset:10240
    s_waitcnt lgkmcnt(6)
    v_mfma_f32_32x32x16_bf16 v[80:95], v[48:51], v[132:135], v[80:95]
    ds_read_b128 v[44:47], v2 offset:11264
    s_waitcnt lgkmcnt(6)
    v_mfma_f32_32x32x16_bf16 v[96:111], v[52:55], v[132:135], v[96:111]
    ds_read_b128 v[48:51], v2 offset:12288
    s_waitcnt vmcnt(15) lgkmcnt(6)
    v_mfma_f32_32x32x16_bf16 v[64:79], v[56:59], v[136:139], v[64:79]
    buffer_load_dwordx4 v[184:187], v1, s[56:59], s38 offen offset:2048 sc1
    ds_read_b128 v[52:55], v2 offset:13312
    s_waitcnt lgkmcnt(6)
    v_mfma_f32_32x32x16_bf16 v[80:95], v[60:63], v[136:139], v[80:95]
    ds_read_b128 v[56:59], v2 offset:14336
    s_waitcnt lgkmcnt(6)
    v_mfma_f32_32x32x16_bf16 v[96:111], v[32:35], v[136:139], v[96:111]
    ds_read_b128 v[60:63], v2 offset:15360
    s_waitcnt vmcnt(15) lgkmcnt(6)
    v_mfma_f32_32x32x16_bf16 v[64:79], v[36:39], v[140:143], v[64:79]
    buffer_load_dwordx4 v[188:191], v1, s[56:59], s38 offen offset:3072 sc1
    s_add_u32 s38, s38, 4096
    ds_read_b128 v[32:35], v2 offset:16384
    s_waitcnt lgkmcnt(6)
    v_mfma_f32_32x32x16_bf16 v[80:95], v[40:43], v[140:143], v[80:95]
    ds_read_b128 v[36:39], v2 offset:17408
    s_waitcnt lgkmcnt(6)
    v_mfma_f32_32x32x16_bf16 v[96:111], v[44:47], v[140:143], v[96:111]
    ds_read_b128 v[40:43], v2 offset:18432
    s_waitcnt vmcnt(15) lgkmcnt(6)
    v_mfma_f32_32x32x16_bf16 v[64:79], v[48:51], v[144:147], v[64:79]
    buffer_load_dwordx4 v[192:195], v1, s[56:59], s38 offen offset:0 sc1
    ds_read_b128 v[44:47], v2 offset:19456
    s_waitcnt lgkmcnt(6)
    v_mfma_f32_32x32x16_bf16 v[80:95], v[52:55], v[144:147], v[80:95]
    ds_read_b128 v[48:51], v2 offset:20480
    s_waitcnt lgkmcnt(6)
    v_mfma_f32_32x32x16_bf16 v[96:111], v[56:59], v[144:147], v[96:111]
    ds_read_b128 v[52:55], v2 offset:21504
    s_waitcnt vmcnt(15) lgkmcnt(6)
    v_mfma_f32_32x32x16_bf16 v[64:79], v[60:63], v[148:151], v[64:79]
    buffer_load_dwordx4 v[196:199], v1, s[56:59], s38 offen offset:1024 sc1
    ds_read_b128 v[56:59], v2 offset:22528
    s_waitcnt lgkmcnt(6)
    v_mfma_f32_32x32x16_bf16 v[80:95], v[32:35], v[148:151], v[80:95]
    ds_read_b128 v[60:63], v2 offset:23552
    s_waitcnt lgkmcnt(6)
    v_mfma_f32_32x32x16_bf16 v[96:111], v[36:39], v[148:151], v[96:111]
    ds_read_b128 v[32:35], v2 offset:24576
    s_waitcnt vmcnt(11) lgkmcnt(6)
    v_mfma_f32_32x32x16_bf16 v[64:79], v[40:43], v[152:155], v[64:79]
    buffer_load_dwordx4 v[200:203], v1, s[56:59], s38 offen offset:2048 sc1
    ds_read_b128 v[36:39], v2 offset:25600
    s_waitcnt lgkmcnt(6)
    v_mfma_f32_32x32x16_bf16 v[80:95], v[44:47], v[152:155], v[80:95]
    ds_read_b128 v[40:43], v2 offset:26624
    s_waitcnt lgkmcnt(6)
    v_mfma_f32_32x32x16_bf16 v[96:111], v[48:51], v[152:155], v[96:111]
    ds_read_b128 v[44:47], v2 offset:27648
    s_waitcnt vmcnt(11) lgkmcnt(6)
    v_mfma_f32_32x32x16_bf16 v[64:79], v[52:55], v[156:159], v[64:79]
    buffer_load_dwordx4 v[204:207], v1, s[56:59], s38 offen offset:3072 sc1
    s_add_u32 s38, s38, 4096
    s_waitcnt vmcnt(14)
    v_add_f32 v8, v8, v10
    v_add_f32 v12, v12, v14
    v_add_f32 v16, v16, v18
    v_add_f32 v20, v20, v22
    v_add_f32 v9, v9, v11
    v_add_f32 v13, v13, v15
    ds_read_b128 v[48:51], v2 offset:28672
    s_waitcnt lgkmcnt(6)
    v_mfma_f32_32x32x16_bf16 v[80:95], v[56:59], v[156:159], v[80:95]
    v_add_f32 v17, v17, v19
    v_add_f32 v21, v21, v23
    v_add_f32 v8, v8, v12
    v_add_f32 v16, v16, v20
    v_add_f32 v9, v9, v13
    v_add_f32 v17, v17, v21
    ds_read_b128 v[52:55], v2 offset:29696
    s_waitcnt lgkmcnt(6)
    v_mfma_f32_32x32x16_bf16 v[96:111], v[60:63], v[156:159], v[96:111]
    v_add_f32 v8, v8, v16
    v_add_f32 v9, v9, v17
    v_mov_b32 v10, v8
    v_mov_b32 v11, v9
    s_nop 0
    v_permlane32_swap_b32 v8, v10
    v_permlane32_swap_b32 v9, v11
    ds_read_b128 v[56:59], v2 offset:30720
    s_waitcnt vmcnt(11) lgkmcnt(6)
    v_mfma_f32_32x32x16_bf16 v[64:79], v[32:35], v[160:163], v[64:79]
    buffer_load_dwordx4 v[208:211], v1, s[56:59], s38 offen offset:0 sc1
    v_add_f32 v8, v8, v10
    v_add_f32 v9, v9, v11
    v_mul_f32 v8, 0xbb000000, v8
    v_mul_f32 v9, 0x3b000000, v9
    v_fma_f32 v9, -v8, v8, v9
    v_max_f32 v9, 0, v9
    ds_read_b128 v[60:63], v2 offset:31744
    s_waitcnt lgkmcnt(6)
    v_mfma_f32_32x32x16_bf16 v[80:95], v[36:39], v[160:163], v[80:95]
    v_mov_b32 v10, 0x2edbe6ff
    v_fmamk_f32 v9, v9, 0x3f800054, v10
    v_rsq_f32 v28, v9
    v_cvt_pk_bf16_f32 v25, v8, 0
    v_lshlrev_b32 v13, 16, v25
    v_sub_f32 v13, v8, v13
    ds_read_b128 v[32:35], v2 offset:32768
    s_waitcnt lgkmcnt(6)
    v_mfma_f32_32x32x16_bf16 v[96:111], v[40:43], v[160:163], v[96:111]
    v_cvt_pk_bf16_f32 v24, v8, v13
    v_cvt_pk_bf16_f32 v26, v8, v13
    v_mul_f32 v14, v9, v28
    v_cvt_pk_bf16_f32 v25, v8, v14
    v_and_b32 v15, 0xffff0000, v25
    v_sub_f32 v15, v14, v15
    ds_read_b128 v[36:39], v2 offset:33792
    s_waitcnt vmcnt(11) lgkmcnt(6)
    v_mfma_f32_32x32x16_bf16 v[64:79], v[44:47], v[164:167], v[64:79]
    buffer_load_dwordx4 v[212:215], v1, s[56:59], s38 offen offset:1024 sc1
    v_cvt_pk_bf16_f32 v27, v8, v15
    v_mov_b32 v31, v14
    v_mul_f32 v29, 0xc0135761, v28
    v_mul_f32 v30, v28, v28
    v_mul_f32 v30, v30, v28
    v_mul_f32 v30, 0xbdd2d3e8, v30
    ds_read_b128 v[40:43], v2 offset:34816
    s_waitcnt lgkmcnt(6)
    v_mfma_f32_32x32x16_bf16 v[80:95], v[48:51], v[164:167], v[80:95]
    v_mov_b32 v28, 0x80000000
    v_writelane_b32 v28, s42, 0
    ds_read_b128 v[44:47], v2 offset:35840
    s_waitcnt lgkmcnt(6)
    v_mfma_f32_32x32x16_bf16 v[96:111], v[52:55], v[164:167], v[96:111]
    ds_read_b128 v[48:51], v2 offset:36864
    s_waitcnt vmcnt(11) lgkmcnt(6)
    v_mfma_f32_32x32x16_bf16 v[64:79], v[56:59], v[168:171], v[64:79]
    buffer_load_dwordx4 v[216:219], v1, s[56:59], s38 offen offset:2048 sc1
    ds_read_b128 v[52:55], v2 offset:37888
    s_waitcnt lgkmcnt(6)
    v_mfma_f32_32x32x16_bf16 v[80:95], v[60:63], v[168:171], v[80:95]
    ds_read_b128 v[56:59], v2 offset:38912
    s_waitcnt lgkmcnt(6)
    v_mfma_f32_32x32x16_bf16 v[96:111], v[32:35], v[168:171], v[96:111]
    ds_read_b128 v[60:63], v2 offset:39936
    s_waitcnt vmcnt(11) lgkmcnt(6)
    v_mfma_f32_32x32x16_bf16 v[64:79], v[36:39], v[172:175], v[64:79]
    buffer_load_dwordx4 v[220:223], v1, s[56:59], s38 offen offset:3072 sc1
    s_add_u32 s38, s38, 4096
    ds_read_b128 v[32:35], v2 offset:40960
    s_waitcnt lgkmcnt(6)
    v_mfma_f32_32x32x16_bf16 v[80:95], v[40:43], v[172:175], v[80:95]
    ds_read_b128 v[36:39], v2 offset:41984
    s_waitcnt lgkmcnt(6)
    v_mfma_f32_32x32x16_bf16 v[96:111], v[44:47], v[172:175], v[96:111]
    ds_read_b128 v[40:43], v2 offset:43008
    s_waitcnt vmcnt(11) lgkmcnt(6)
    v_mfma_f32_32x32x16_bf16 v[64:79], v[48:51], v[176:179], v[64:79]
    buffer_load_dwordx4 v[224:227], v1, s[56:59], s38 offen offset:0 sc1
    ds_read_b128 v[44:47], v2 offset:44032
    s_waitcnt lgkmcnt(6)
    v_mfma_f32_32x32x16_bf16 v[80:95], v[52:55], v[176:179], v[80:95]
    ds_read_b128 v[48:51], v2 offset:45056
    s_waitcnt lgkmcnt(6)
    v_mfma_f32_32x32x16_bf16 v[96:111], v[56:59], v[176:179], v[96:111]
    ds_read_b128 v[52:55], v2 offset:46080
    s_waitcnt vmcnt(11) lgkmcnt(6)
    v_mfma_f32_32x32x16_bf16 v[64:79], v[60:63], v[180:183], v[64:79]
    buffer_load_dwordx4 v[228:231], v1, s[56:59], s38 offen offset:1024 sc1
    ds_read_b128 v[56:59], v2 offset:47104
    s_waitcnt lgkmcnt(6)
    v_mfma_f32_32x32x16_bf16 v[80:95], v[32:35], v[180:183], v[80:95]
    ds_read_b128 v[60:63], v2 offset:48128
    s_waitcnt lgkmcnt(6)
    v_mfma_f32_32x32x16_bf16 v[96:111], v[36:39], v[180:183], v[96:111]
    ds_read_b128 v[32:35], v2 offset:49152
    s_waitcnt vmcnt(11) lgkmcnt(6)
    v_mfma_f32_32x32x16_bf16 v[64:79], v[40:43], v[184:187], v[64:79]
    buffer_load_dwordx4 v[232:235], v1, s[56:59], s38 offen offset:2048 sc1
    ds_read_b128 v[36:39], v2 offset:50176
    s_waitcnt lgkmcnt(6)
    v_mfma_f32_32x32x16_bf16 v[80:95], v[44:47], v[184:187], v[80:95]
    ds_read_b128 v[40:43], v2 offset:51200
    s_waitcnt lgkmcnt(6)
    v_mfma_f32_32x32x16_bf16 v[96:111], v[48:51], v[184:187], v[96:111]
    ds_read_b128 v[44:47], v2 offset:52224
    s_waitcnt vmcnt(11) lgkmcnt(6)
    v_mfma_f32_32x32x16_bf16 v[64:79], v[52:55], v[188:191], v[64:79]
    buffer_load_dwordx4 v[236:239], v1, s[56:59], s38 offen offset:3072 sc1
    s_add_u32 s38, s38, 4096
    ds_read_b128 v[48:51], v2 offset:53248
    s_waitcnt lgkmcnt(6)
    v_mfma_f32_32x32x16_bf16 v[80:95], v[56:59], v[188:191], v[80:95]
    ds_read_b128 v[52:55], v2 offset:54272
    s_waitcnt lgkmcnt(6)
    v_mfma_f32_32x32x16_bf16 v[96:111], v[60:63], v[188:191], v[96:111]
    ds_read_b128 v[56:59], v2 offset:55296
    s_waitcnt vmcnt(11) lgkmcnt(6)
    v_mfma_f32_32x32x16_bf16 v[64:79], v[32:35], v[192:195], v[64:79]
    buffer_load_dwordx4 v[240:243], v1, s[56:59], s38 offen offset:0 sc1
    ds_read_b128 v[60:63], v2 offset:56320
    s_waitcnt lgkmcnt(6)
    v_mfma_f32_32x32x16_bf16 v[80:95], v[36:39], v[192:195], v[80:95]
    ds_read_b128 v[32:35], v2 offset:57344
    s_waitcnt lgkmcnt(6)
    v_mfma_f32_32x32x16_bf16 v[96:111], v[40:43], v[192:195], v[96:111]
    ds_read_b128 v[36:39], v2 offset:58368
    s_waitcnt vmcnt(11) lgkmcnt(6)
    v_mfma_f32_32x32x16_bf16 v[64:79], v[44:47], v[196:199], v[64:79]
    buffer_load_dwordx4 v[244:247], v1, s[56:59], s38 offen offset:1024 sc1
    ds_read_b128 v[40:43], v2 offset:59392
    s_waitcnt lgkmcnt(6)
    v_mfma_f32_32x32x16_bf16 v[80:95], v[48:51], v[196:199], v[80:95]
    ds_read_b128 v[44:47], v2 offset:60416
    s_waitcnt lgkmcnt(6)
    v_mfma_f32_32x32x16_bf16 v[96:111], v[52:55], v[196:199], v[96:111]
    ds_read_b128 v[48:51], v2 offset:61440
    s_waitcnt vmcnt(11) lgkmcnt(6)
    v_mfma_f32_32x32x16_bf16 v[64:79], v[56:59], v[200:203], v[64:79]
    buffer_load_dwordx4 v[248:251], v1, s[56:59], s38 offen offset:2048 sc1
    ds_read_b128 v[52:55], v2 offset:62464
    s_waitcnt lgkmcnt(6)
    v_mfma_f32_32x32x16_bf16 v[80:95], v[60:63], v[200:203], v[80:95]
    ds_read_b128 v[56:59], v2 offset:63488
    s_waitcnt lgkmcnt(6)
    v_mfma_f32_32x32x16_bf16 v[96:111], v[32:35], v[200:203], v[96:111]
    ds_read_b128 v[60:63], v2 offset:64512
    s_waitcnt vmcnt(11) lgkmcnt(6)
    v_mfma_f32_32x32x16_bf16 v[64:79], v[36:39], v[204:207], v[64:79]
    buffer_load_dwordx4 v[252:255], v1, s[56:59], s38 offen offset:3072 sc1
    s_add_u32 s38, s38, 4096
    ds_read_b128 v[32:35], v3 offset:0
    s_waitcnt lgkmcnt(6)
    v_mfma_f32_32x32x16_bf16 v[80:95], v[40:43], v[204:207], v[80:95]
    ds_read_b128 v[36:39], v3 offset:1024
    s_waitcnt lgkmcnt(6)
    v_mfma_f32_32x32x16_bf16 v[96:111], v[44:47], v[204:207], v[96:111]
    ds_read_b128 v[40:43], v3 offset:2048
    s_waitcnt vmcnt(11) lgkmcnt(6)
    v_mfma_f32_32x32x16_bf16 v[64:79], v[48:51], v[208:211], v[64:79]
    ds_read_b128 v[44:47], v3 offset:3072
    s_waitcnt lgkmcnt(6)
    v_mfma_f32_32x32x16_bf16 v[80:95], v[52:55], v[208:211], v[80:95]
    ds_read_b128 v[48:51], v3 offset:4096
    s_waitcnt lgkmcnt(6)
    v_mfma_f32_32x32x16_bf16 v[96:111], v[56:59], v[208:211], v[96:111]
    s_barrier
    ds_read_b128 v[52:55], v3 offset:5120
    s_waitcnt vmcnt(10) lgkmcnt(6)
    v_mfma_f32_32x32x16_bf16 v[64:79], v[60:63], v[212:215], v[64:79]
    ds_read_b128 v[56:59], v3 offset:6144
    s_waitcnt lgkmcnt(6)
    v_mfma_f32_32x32x16_bf16 v[80:95], v[32:35], v[212:215], v[80:95]
    ds_read_b128 v[60:63], v3 offset:7168
    s_waitcnt lgkmcnt(6)
    v_mfma_f32_32x32x16_bf16 v[96:111], v[36:39], v[212:215], v[96:111]
    ds_read_b128 v[32:35], v3 offset:8192
    s_waitcnt vmcnt(9) lgkmcnt(6)
    v_mfma_f32_32x32x16_bf16 v[64:79], v[40:43], v[216:219], v[64:79]
    ds_read_b128 v[36:39], v3 offset:9216
    s_waitcnt lgkmcnt(6)
    v_mfma_f32_32x32x16_bf16 v[80:95], v[44:47], v[216:219], v[80:95]
    ds_read_b128 v[40:43], v3 offset:10240
    s_waitcnt lgkmcnt(6)
    v_mfma_f32_32x32x16_bf16 v[96:111], v[48:51], v[216:219], v[96:111]
    ds_read_b128 v[44:47], v3 offset:11264
    s_waitcnt vmcnt(8) lgkmcnt(6)
    v_mfma_f32_32x32x16_bf16 v[64:79], v[52:55], v[220:223], v[64:79]
    ds_read_b128 v[48:51], v3 offset:12288
    s_waitcnt lgkmcnt(6)
    v_mfma_f32_32x32x16_bf16 v[80:95], v[56:59], v[220:223], v[80:95]
    ds_read_b128 v[52:55], v3 offset:13312
    s_waitcnt lgkmcnt(6)
    v_mfma_f32_32x32x16_bf16 v[96:111], v[60:63], v[220:223], v[96:111]
    ds_read_b128 v[56:59], v3 offset:14336
    s_waitcnt vmcnt(7) lgkmcnt(6)
    v_mfma_f32_32x32x16_bf16 v[64:79], v[32:35], v[224:227], v[64:79]
    ds_read_b128 v[60:63], v3 offset:15360
    s_waitcnt lgkmcnt(6)
    v_mfma_f32_32x32x16_bf16 v[80:95], v[36:39], v[224:227], v[80:95]
    ds_read_b128 v[32:35], v3 offset:16384
    s_waitcnt lgkmcnt(6)
    v_mfma_f32_32x32x16_bf16 v[96:111], v[40:43], v[224:227], v[96:111]
    ds_read_b128 v[36:39], v3 offset:17408
    s_waitcnt vmcnt(6) lgkmcnt(6)
    v_mfma_f32_32x32x16_bf16 v[64:79], v[44:47], v[228:231], v[64:79]
    ds_read_b128 v[40:43], v3 offset:18432
    s_waitcnt lgkmcnt(6)
    v_mfma_f32_32x32x16_bf16 v[80:95], v[48:51], v[228:231], v[80:95]
    ds_read_b128 v[44:47], v3 offset:19456
    s_waitcnt lgkmcnt(6)
    v_mfma_f32_32x32x16_bf16 v[96:111], v[52:55], v[228:231], v[96:111]
    ds_read_b128 v[48:51], v3 offset:20480
    s_waitcnt vmcnt(5) lgkmcnt(6)
    v_mfma_f32_32x32x16_bf16 v[64:79], v[56:59], v[232:235], v[64:79]
    ds_read_b128 v[52:55], v3 offset:21504
    s_waitcnt lgkmcnt(6)
    v_mfma_f32_32x32x16_bf16 v[80:95], v[60:63], v[232:235], v[80:95]
    ds_read_b128 v[56:59], v3 offset:22528
    s_waitcnt lgkmcnt(6)
    v_mfma_f32_32x32x16_bf16 v[96:111], v[32:35], v[232:235], v[96:111]
    ds_read_b128 v[60:63], v3 offset:23552
    s_waitcnt vmcnt(4) lgkmcnt(6)
    v_mfma_f32_32x32x16_bf16 v[64:79], v[36:39], v[236:239], v[64:79]
    ds_read_b128 v[32:35], v3 offset:24576
    s_waitcnt lgkmcnt(6)
    v_mfma_f32_32x32x16_bf16 v[80:95], v[40:43], v[236:239], v[80:95]
    ds_read_b128 v[36:39], v3 offset:25600
    s_waitcnt lgkmcnt(6)
    v_mfma_f32_32x32x16_bf16 v[96:111], v[44:47], v[236:239], v[96:111]
    ds_read_b128 v[40:43], v3 offset:26624
    s_waitcnt vmcnt(3) lgkmcnt(6)
    v_mfma_f32_32x32x16_bf16 v[64:79], v[48:51], v[240:243], v[64:79]
    ds_read_b128 v[44:47], v3 offset:27648
    s_waitcnt lgkmcnt(6)
    v_mfma_f32_32x32x16_bf16 v[80:95], v[52:55], v[240:243], v[80:95]
    ds_read_b128 v[48:51], v3 offset:28672
    s_waitcnt lgkmcnt(6)
    v_mfma_f32_32x32x16_bf16 v[96:111], v[56:59], v[240:243], v[96:111]
    ds_read_b128 v[52:55], v3 offset:29696
    s_waitcnt vmcnt(2) lgkmcnt(6)
    v_mfma_f32_32x32x16_bf16 v[64:79], v[60:63], v[244:247], v[64:79]
    ds_read_b128 v[56:59], v3 offset:30720
    s_waitcnt lgkmcnt(6)
    v_mfma_f32_32x32x16_bf16 v[80:95], v[32:35], v[244:247], v[80:95]
    ds_read_b128 v[60:63], v3 offset:31744
    s_waitcnt lgkmcnt(6)
    v_mfma_f32_32x32x16_bf16 v[96:111], v[36:39], v[244:247], v[96:111]
    v_and_b32 v35, 15, v0
    v_mad_i32_i24 v35, v35, -8, v3
    ds_read_b64 v[32:33], v35 offset:32768
    ds_read_b64 v[34:35], v35 offset:32896
    s_waitcnt vmcnt(1) lgkmcnt(7)
    v_mfma_f32_32x32x16_bf16 v[64:79], v[40:43], v[248:251], v[64:79]
    v_and_b32 v39, 15, v0
    v_mad_i32_i24 v39, v39, -8, v3
    ds_read_b64 v[36:37], v39 offset:33792
    ds_read_b64 v[38:39], v39 offset:33920
    s_waitcnt lgkmcnt(8)
    v_mfma_f32_32x32x16_bf16 v[80:95], v[44:47], v[248:251], v[80:95]
    v_and_b32 v43, 15, v0
    v_mad_i32_i24 v43, v43, -8, v3
    ds_read_b64 v[40:41], v43 offset:34816
    ds_read_b64 v[42:43], v43 offset:34944
    s_waitcnt lgkmcnt(9)
    v_mfma_f32_32x32x16_bf16 v[96:111], v[48:51], v[248:251], v[96:111]
    ds_read_b128 v[44:47], v3 offset:35840
    s_waitcnt vmcnt(0) lgkmcnt(9)
    v_mfma_f32_32x32x16_bf16 v[64:79], v[52:55], v[252:255], v[64:79]
    ds_read_b128 v[48:51], v3 offset:36352
    s_waitcnt lgkmcnt(9)
    v_mfma_f32_32x32x16_bf16 v[80:95], v[56:59], v[252:255], v[80:95]
    ds_read_b128 v[52:55], v3 offset:36864
    s_waitcnt lgkmcnt(9)
    v_mfma_f32_32x32x16_bf16 v[96:111], v[60:63], v[252:255], v[96:111]
    ds_read_b128 v[56:59], v3 offset:37376
    s_waitcnt lgkmcnt(8)
    v_mfma_f32_32x32x16_bf16 v[64:79], v[32:35], v[24:27], v[64:79]
    ds_read_b128 v[60:63], v3 offset:37888
    s_waitcnt lgkmcnt(7)
    v_mfma_f32_32x32x16_bf16 v[80:95], v[36:39], v[24:27], v[80:95]
    s_setprio 1
    s_nop 7
    v_mul_f32 v8, v64, v64
    v_mul_f32 v9, v65, v65
    v_mul_f32 v10, v66, v66
    v_mul_f32 v11, v67, v67
    v_mul_f32 v12, v68, v68
    v_mul_f32 v13, v69, v69
    v_mul_f32 v14, v70, v70
    v_mul_f32 v15, v71, v71
    v_fma_f32 v8, v8, v30, v29
    v_fma_f32 v9, v9, v30, v29
    v_fma_f32 v10, v10, v30, v29
    v_fma_f32 v11, v11, v30, v29
    v_fma_f32 v12, v12, v30, v29
    v_fma_f32 v13, v13, v30, v29
    v_fma_f32 v14, v14, v30, v29
    v_fma_f32 v15, v15, v30, v29
    ds_read_b128 v[32:35], v3 offset:38400
    s_waitcnt lgkmcnt(6)
    v_mfma_f32_32x32x16_bf16 v[96:111], v[40:43], v[24:27], v[96:111]
    v_mul_f32 v8, v8, v64
    v_mul_f32 v9, v9, v65
    v_mul_f32 v10, v10, v66
    v_mul_f32 v11, v11, v67
    v_mul_f32 v12, v12, v68
    v_mul_f32 v13, v13, v69
    v_mul_f32 v14, v14, v70
    v_mul_f32 v15, v15, v71
    v_exp_f32 v8, v8
    v_exp_f32 v9, v9
    v_exp_f32 v10, v10
    v_exp_f32 v11, v11
    ds_read_b128 v[36:39], v3 offset:38912
    s_waitcnt lgkmcnt(6)
    v_mfma_f32_32x32x16_bf16 v[112:127], v[44:47], v[128:131], 0
    v_exp_f32 v12, v12
    v_exp_f32 v13, v13
    v_exp_f32 v14, v14
    v_exp_f32 v15, v15
    v_fma_f32 v8, v8, v31, v31
    v_fma_f32 v9, v9, v31, v31
    v_fma_f32 v10, v10, v31, v31
    v_fma_f32 v11, v11, v31, v31
    v_fma_f32 v12, v12, v31, v31
    v_fma_f32 v13, v13, v31, v31
    v_fma_f32 v14, v14, v31, v31
    v_fma_f32 v15, v15, v31, v31
    ds_read_b128 v[40:43], v3 offset:39424
    s_waitcnt lgkmcnt(6)
    v_mfma_f32_32x32x16_bf16 v[112:127], v[48:51], v[132:135], v[112:127]
    v_rcp_f32 v8, v8
    v_rcp_f32 v9, v9
    v_rcp_f32 v10, v10
    v_rcp_f32 v11, v11
    v_rcp_f32 v12, v12
    v_rcp_f32 v13, v13
    v_rcp_f32 v14, v14
    v_rcp_f32 v15, v15
    ds_read_b128 v[44:47], v3 offset:39936
    s_waitcnt lgkmcnt(6)
    v_mfma_f32_32x32x16_bf16 v[112:127], v[52:55], v[136:139], v[112:127]
    v_mul_f32 v64, v8, v64
    v_mul_f32 v65, v9, v65
    v_mul_f32 v66, v10, v66
    v_mul_f32 v67, v11, v67
    v_mul_f32 v68, v12, v68
    v_mul_f32 v69, v13, v69
    ds_read_b128 v[48:51], v3 offset:40448
    s_waitcnt lgkmcnt(6)
    v_mfma_f32_32x32x16_bf16 v[112:127], v[56:59], v[140:143], v[112:127]
    v_mul_f32 v70, v14, v70
    v_mul_f32 v71, v15, v71
    v_cvt_pk_bf16_f32 v64, v64, v65
    v_cvt_pk_bf16_f32 v65, v66, v67
    v_cvt_pk_bf16_f32 v66, v68, v69
    v_cvt_pk_bf16_f32 v67, v70, v71
    ds_read_b128 v[52:55], v3 offset:40960
    s_waitcnt lgkmcnt(6)
    v_mfma_f32_32x32x16_bf16 v[112:127], v[60:63], v[144:147], v[112:127]
    buffer_store_dwordx4 v[64:67], v1, s[56:59], s40 offen offset:0
    v_mul_f32 v16, v72, v72
    v_mul_f32 v17, v73, v73
    v_mul_f32 v18, v74, v74
    v_mul_f32 v19, v75, v75
    v_mul_f32 v20, v76, v76
    ds_read_b128 v[56:59], v3 offset:41472
    s_waitcnt lgkmcnt(6)
    v_mfma_f32_32x32x16_bf16 v[112:127], v[32:35], v[148:151], v[112:127]
    v_mul_f32 v21, v77, v77
    v_mul_f32 v22, v78, v78
    v_mul_f32 v23, v79, v79
    v_fma_f32 v16, v16, v30, v29
    v_fma_f32 v17, v17, v30, v29
    v_fma_f32 v18, v18, v30, v29
    ds_read_b128 v[60:63], v3 offset:41984
    s_waitcnt lgkmcnt(6)
    v_mfma_f32_32x32x16_bf16 v[112:127], v[36:39], v[152:155], v[112:127]
    v_fma_f32 v19, v19, v30, v29
    v_fma_f32 v20, v20, v30, v29
    v_fma_f32 v21, v21, v30, v29
    v_fma_f32 v22, v22, v30, v29
    v_fma_f32 v23, v23, v30, v29
    v_mul_f32 v16, v16, v72
    ds_read_b128 v[32:35], v3 offset:42496
    s_waitcnt lgkmcnt(6)
    v_mfma_f32_32x32x16_bf16 v[112:127], v[40:43], v[156:159], v[112:127]
    v_mul_f32 v17, v17, v73
    v_mul_f32 v18, v18, v74
    v_mul_f32 v19, v19, v75
    v_mul_f32 v20, v20, v76
    v_mul_f32 v21, v21, v77
    v_mul_f32 v22, v22, v78
    ds_read_b128 v[36:39], v3 offset:43008
    s_waitcnt lgkmcnt(6)
    v_mfma_f32_32x32x16_bf16 v[112:127], v[44:47], v[160:163], v[112:127]
    v_mul_f32 v23, v23, v79
    v_exp_f32 v16, v16
    v_exp_f32 v17, v17
    v_exp_f32 v18, v18
    ds_read_b128 v[40:43], v3 offset:43520
    s_waitcnt lgkmcnt(6)
    v_mfma_f32_32x32x16_bf16 v[112:127], v[48:51], v[164:167], v[112:127]
    v_exp_f32 v19, v19
    v_exp_f32 v20, v20
    v_exp_f32 v21, v21
    ds_read_b128 v[44:47], v3 offset:44032
    s_waitcnt lgkmcnt(6)
    v_mfma_f32_32x32x16_bf16 v[112:127], v[52:55], v[168:171], v[112:127]
    v_exp_f32 v22, v22
    v_exp_f32 v23, v23
    v_fma_f32 v16, v16, v31, v31
    v_fma_f32 v17, v17, v31, v31
    ds_read_b128 v[48:51], v3 offset:44544
    s_waitcnt lgkmcnt(6)
    v_mfma_f32_32x32x16_bf16 v[112:127], v[56:59], v[172:175], v[112:127]
    v_fma_f32 v18, v18, v31, v31
    v_fma_f32 v19, v19, v31, v31
    v_fma_f32 v20, v20, v31, v31
    v_fma_f32 v21, v21, v31, v31
    v_fma_f32 v22, v22, v31, v31
    v_fma_f32 v23, v23, v31, v31
    ds_read_b128 v[52:55], v3 offset:45056
    s_waitcnt lgkmcnt(6)
    v_mfma_f32_32x32x16_bf16 v[112:127], v[60:63], v[176:179], v[112:127]
    v_rcp_f32 v16, v16
    v_rcp_f32 v17, v17
    v_rcp_f32 v18, v18
    ds_read_b128 v[56:59], v3 offset:45568
    s_waitcnt lgkmcnt(6)
    v_mfma_f32_32x32x16_bf16 v[112:127], v[32:35], v[180:183], v[112:127]
    v_rcp_f32 v19, v19
    v_rcp_f32 v20, v20
    v_rcp_f32 v21, v21
    ds_read_b128 v[60:63], v3 offset:46080
    s_waitcnt lgkmcnt(6)
    v_mfma_f32_32x32x16_bf16 v[112:127], v[36:39], v[184:187], v[112:127]
    v_rcp_f32 v22, v22
    v_rcp_f32 v23, v23
    v_mul_f32 v72, v16, v72
    v_mul_f32 v73, v17, v73
    ds_read_b128 v[32:35], v3 offset:46592
    s_waitcnt lgkmcnt(6)
    v_mfma_f32_32x32x16_bf16 v[112:127], v[40:43], v[188:191], v[112:127]
    v_mul_f32 v74, v18, v74
    v_mul_f32 v75, v19, v75
    v_mul_f32 v76, v20, v76
    v_mul_f32 v77, v21, v77
    v_mul_f32 v78, v22, v78
    v_mul_f32 v79, v23, v79
    ds_read_b128 v[36:39], v3 offset:47104
    s_waitcnt lgkmcnt(6)
    v_mfma_f32_32x32x16_bf16 v[112:127], v[44:47], v[192:195], v[112:127]
    v_cvt_pk_bf16_f32 v72, v72, v73
    v_cvt_pk_bf16_f32 v73, v74, v75
    v_cvt_pk_bf16_f32 v74, v76, v77
    v_cvt_pk_bf16_f32 v75, v78, v79
    buffer_store_dwordx4 v[72:75], v1, s[56:59], s40 offen offset:1024
    v_mul_f32 v8, v80, v80
    ds_read_b128 v[40:43], v3 offset:47616
    s_waitcnt lgkmcnt(6)
    v_mfma_f32_32x32x16_bf16 v[112:127], v[48:51], v[196:199], v[112:127]
    v_mul_f32 v9, v81, v81
    v_mul_f32 v10, v82, v82
    v_mul_f32 v11, v83, v83
    v_mul_f32 v12, v84, v84
    v_mul_f32 v13, v85, v85
    v_mul_f32 v14, v86, v86
    ds_read_b128 v[44:47], v3 offset:48128
    s_waitcnt lgkmcnt(6)
    v_mfma_f32_32x32x16_bf16 v[112:127], v[52:55], v[200:203], v[112:127]
    v_mul_f32 v15, v87, v87
    v_fma_f32 v8, v8, v30, v29
    v_fma_f32 v9, v9, v30, v29
    v_fma_f32 v10, v10, v30, v29
    v_mov_b32 v68, 1
    s_waitcnt vmcnt(1)
    buffer_store_dword v68, v28, s[8:11], s43 offen
    v_fma_f32 v11, v11, v30, v29
    ds_read_b128 v[48:51], v3 offset:48640
    s_waitcnt lgkmcnt(6)
    v_mfma_f32_32x32x16_bf16 v[112:127], v[56:59], v[204:207], v[112:127]
    v_fma_f32 v12, v12, v30, v29
    v_fma_f32 v13, v13, v30, v29
    v_fma_f32 v14, v14, v30, v29
    v_fma_f32 v15, v15, v30, v29
    v_mul_f32 v8, v8, v80
    v_mul_f32 v9, v9, v81
    ds_read_b128 v[52:55], v3 offset:49152
    s_waitcnt lgkmcnt(6)
    v_mfma_f32_32x32x16_bf16 v[112:127], v[60:63], v[208:211], v[112:127]
    v_mul_f32 v10, v10, v82
    v_mul_f32 v11, v11, v83
    v_mul_f32 v12, v12, v84
    v_mul_f32 v13, v13, v85
    v_mul_f32 v14, v14, v86
    v_mul_f32 v15, v15, v87
    ds_read_b128 v[56:59], v3 offset:49664
    s_waitcnt lgkmcnt(6)
    v_mfma_f32_32x32x16_bf16 v[112:127], v[32:35], v[212:215], v[112:127]
    v_exp_f32 v8, v8
    v_exp_f32 v9, v9
    v_exp_f32 v10, v10
    ds_read_b128 v[60:63], v3 offset:50176
    s_waitcnt lgkmcnt(6)
    v_mfma_f32_32x32x16_bf16 v[112:127], v[36:39], v[216:219], v[112:127]
    v_exp_f32 v11, v11
    v_exp_f32 v12, v12
    v_exp_f32 v13, v13
    ds_read_b128 v[32:35], v3 offset:50688
    s_waitcnt lgkmcnt(6)
    v_mfma_f32_32x32x16_bf16 v[112:127], v[40:43], v[220:223], v[112:127]
    v_exp_f32 v14, v14
    v_exp_f32 v15, v15
    v_fma_f32 v8, v8, v31, v31
    v_fma_f32 v9, v9, v31, v31
    ds_read_b128 v[36:39], v3 offset:51200
    s_waitcnt lgkmcnt(6)
    v_mfma_f32_32x32x16_bf16 v[112:127], v[44:47], v[224:227], v[112:127]
    v_fma_f32 v10, v10, v31, v31
    v_fma_f32 v11, v11, v31, v31
    v_fma_f32 v12, v12, v31, v31
    v_fma_f32 v13, v13, v31, v31
    v_fma_f32 v14, v14, v31, v31
    v_fma_f32 v15, v15, v31, v31
    ds_read_b128 v[40:43], v3 offset:51712
    s_waitcnt lgkmcnt(6)
    v_mfma_f32_32x32x16_bf16 v[112:127], v[48:51], v[228:231], v[112:127]
    v_rcp_f32 v8, v8
    v_rcp_f32 v9, v9
    v_rcp_f32 v10, v10
    v_and_b32 v47, 15, v0
    v_mad_i32_i24 v47, v47, -8, v3
    ds_read_b64 v[44:45], v47 offset:52224
    ds_read_b64 v[46:47], v47 offset:52352
    s_waitcnt lgkmcnt(7)
    v_mfma_f32_32x32x16_bf16 v[112:127], v[52:55], v[232:235], v[112:127]
    v_rcp_f32 v11, v11
    v_rcp_f32 v12, v12
    v_rcp_f32 v13, v13
    s_waitcnt lgkmcnt(6)
    v_mfma_f32_32x32x16_bf16 v[112:127], v[56:59], v[236:239], v[112:127]
    v_rcp_f32 v14, v14
    v_rcp_f32 v15, v15
    v_mul_f32 v80, v8, v80
    v_mul_f32 v81, v9, v81
    s_waitcnt lgkmcnt(5)
    v_mfma_f32_32x32x16_bf16 v[112:127], v[60:63], v[240:243], v[112:127]
    v_mul_f32 v82, v10, v82
    v_mul_f32 v83, v11, v83
    v_mul_f32 v84, v12, v84
    v_mul_f32 v85, v13, v85
    v_mul_f32 v86, v14, v86
    v_mul_f32 v87, v15, v87
    s_waitcnt lgkmcnt(4)
    v_mfma_f32_32x32x16_bf16 v[112:127], v[32:35], v[244:247], v[112:127]
    v_cvt_pk_bf16_f32 v80, v80, v81
    v_cvt_pk_bf16_f32 v81, v82, v83
    v_cvt_pk_bf16_f32 v82, v84, v85
    v_cvt_pk_bf16_f32 v83, v86, v87
    buffer_store_dwordx4 v[80:83], v1, s[56:59], s40 offen offset:2048
    v_mul_f32 v16, v88, v88
    s_waitcnt lgkmcnt(3)
    v_mfma_f32_32x32x16_bf16 v[112:127], v[36:39], v[248:251], v[112:127]
    v_mul_f32 v17, v89, v89
    v_mul_f32 v18, v90, v90
    v_mul_f32 v19, v91, v91
    v_mul_f32 v20, v92, v92
    v_mul_f32 v21, v93, v93
    v_mul_f32 v22, v94, v94
    s_waitcnt lgkmcnt(2)
    v_mfma_f32_32x32x16_bf16 v[112:127], v[40:43], v[252:255], v[112:127]
    v_mul_f32 v23, v95, v95
    v_fma_f32 v16, v16, v30, v29
    v_fma_f32 v17, v17, v30, v29
    v_fma_f32 v18, v18, v30, v29
    v_fma_f32 v19, v19, v30, v29
    v_fma_f32 v20, v20, v30, v29
    s_waitcnt lgkmcnt(0)
    v_mfma_f32_32x32x16_bf16 v[112:127], v[44:47], v[24:27], v[112:127]
    v_fma_f32 v21, v21, v30, v29
    v_fma_f32 v22, v22, v30, v29
    v_fma_f32 v23, v23, v30, v29
    v_mul_f32 v16, v16, v88
    v_mul_f32 v17, v17, v89
    v_mul_f32 v18, v18, v90
    v_mul_f32 v19, v19, v91
    v_mul_f32 v20, v20, v92
    v_mul_f32 v21, v21, v93
    v_mul_f32 v22, v22, v94
    v_mul_f32 v23, v23, v95
    v_exp_f32 v16, v16
    v_exp_f32 v17, v17
    v_exp_f32 v18, v18
    v_exp_f32 v19, v19
    v_exp_f32 v20, v20
    v_exp_f32 v21, v21
    v_exp_f32 v22, v22
    v_exp_f32 v23, v23
    v_fma_f32 v16, v16, v31, v31
    v_fma_f32 v17, v17, v31, v31
    v_fma_f32 v18, v18, v31, v31
    v_fma_f32 v19, v19, v31, v31
    v_fma_f32 v20, v20, v31, v31
    v_fma_f32 v21, v21, v31, v31
    v_fma_f32 v22, v22, v31, v31
    v_fma_f32 v23, v23, v31, v31
    v_rcp_f32 v16, v16
    v_rcp_f32 v17, v17
    v_rcp_f32 v18, v18
    v_rcp_f32 v19, v19
    v_rcp_f32 v20, v20
    v_rcp_f32 v21, v21
    v_rcp_f32 v22, v22
    v_rcp_f32 v23, v23
    v_mul_f32 v88, v16, v88
    v_mul_f32 v89, v17, v89
    v_mul_f32 v90, v18, v90
    v_mul_f32 v91, v19, v91
    v_mul_f32 v92, v20, v92
    v_mul_f32 v93, v21, v93
    v_mul_f32 v94, v22, v94
    v_mul_f32 v95, v23, v95
    v_cvt_pk_bf16_f32 v88, v88, v89
    v_cvt_pk_bf16_f32 v89, v90, v91
    v_cvt_pk_bf16_f32 v90, v92, v93
    v_cvt_pk_bf16_f32 v91, v94, v95
    buffer_store_dwordx4 v[88:91], v1, s[56:59], s40 offen offset:3072
    v_mul_f32 v8, v96, v96
    v_mul_f32 v9, v97, v97
    v_mul_f32 v10, v98, v98
    v_mul_f32 v11, v99, v99
    v_mul_f32 v12, v100, v100
    v_mul_f32 v13, v101, v101
    v_mul_f32 v14, v102, v102
    v_mul_f32 v15, v103, v103
    v_fma_f32 v8, v8, v30, v29
    v_fma_f32 v9, v9, v30, v29
    v_fma_f32 v10, v10, v30, v29
    v_fma_f32 v11, v11, v30, v29
    v_fma_f32 v12, v12, v30, v29
    v_fma_f32 v13, v13, v30, v29
    v_fma_f32 v14, v14, v30, v29
    v_fma_f32 v15, v15, v30, v29
    v_mul_f32 v8, v8, v96
    v_mul_f32 v9, v9, v97
    v_mul_f32 v10, v10, v98
    v_mul_f32 v11, v11, v99
    v_mul_f32 v12, v12, v100
    v_mov_b32 v76, 2
    s_waitcnt vmcnt(3)
    buffer_store_dword v76, v28, s[8:11], s43 offen
    v_mul_f32 v13, v13, v101
    v_mul_f32 v14, v14, v102
    v_mul_f32 v15, v15, v103
    v_exp_f32 v8, v8
    v_exp_f32 v9, v9
    v_exp_f32 v10, v10
    v_exp_f32 v11, v11
    v_exp_f32 v12, v12
    v_exp_f32 v13, v13
    v_exp_f32 v14, v14
    v_exp_f32 v15, v15
    v_fma_f32 v8, v8, v31, v31
    v_fma_f32 v9, v9, v31, v31
    v_fma_f32 v10, v10, v31, v31
    v_fma_f32 v11, v11, v31, v31
    v_fma_f32 v12, v12, v31, v31
    v_fma_f32 v13, v13, v31, v31
    v_fma_f32 v14, v14, v31, v31
    v_fma_f32 v15, v15, v31, v31
    v_rcp_f32 v8, v8
    v_rcp_f32 v9, v9
    v_rcp_f32 v10, v10
    v_rcp_f32 v11, v11
    v_rcp_f32 v12, v12
    v_rcp_f32 v13, v13
    v_rcp_f32 v14, v14
    v_rcp_f32 v15, v15
    v_mul_f32 v96, v8, v96
    v_mul_f32 v97, v9, v97
    v_mul_f32 v98, v10, v98
    v_mul_f32 v99, v11, v99
    v_mul_f32 v100, v12, v100
    v_mul_f32 v101, v13, v101
    v_mul_f32 v102, v14, v102
    v_mul_f32 v103, v15, v103
    v_cvt_pk_bf16_f32 v96, v96, v97
    v_cvt_pk_bf16_f32 v97, v98, v99
    v_cvt_pk_bf16_f32 v98, v100, v101
    v_cvt_pk_bf16_f32 v99, v102, v103
    buffer_store_dwordx4 v[96:99], v1, s[56:59], s41 offen offset:0
    v_mul_f32 v16, v104, v104
    v_mul_f32 v17, v105, v105
    v_mul_f32 v18, v106, v106
    v_mul_f32 v19, v107, v107
    v_mul_f32 v20, v108, v108
    v_mul_f32 v21, v109, v109
    v_mul_f32 v22, v110, v110
    v_mul_f32 v23, v111, v111
    v_fma_f32 v16, v16, v30, v29
    v_fma_f32 v17, v17, v30, v29
    v_fma_f32 v18, v18, v30, v29
    v_fma_f32 v19, v19, v30, v29
    v_fma_f32 v20, v20, v30, v29
    v_fma_f32 v21, v21, v30, v29
    v_fma_f32 v22, v22, v30, v29
    v_fma_f32 v23, v23, v30, v29
    v_mul_f32 v16, v16, v104
    v_mul_f32 v17, v17, v105
    v_mul_f32 v18, v18, v106
    v_mul_f32 v19, v19, v107
    v_mul_f32 v20, v20, v108
    v_mov_b32 v84, 3
    s_waitcnt vmcnt(3)
    buffer_store_dword v84, v28, s[8:11], s43 offen
    v_mul_f32 v21, v21, v109
    v_mul_f32 v22, v22, v110
    v_mul_f32 v23, v23, v111
    v_exp_f32 v16, v16
    v_exp_f32 v17, v17
    v_exp_f32 v18, v18
    v_exp_f32 v19, v19
    v_exp_f32 v20, v20
    v_exp_f32 v21, v21
    v_exp_f32 v22, v22
    v_exp_f32 v23, v23
    v_fma_f32 v16, v16, v31, v31
    v_fma_f32 v17, v17, v31, v31
    v_fma_f32 v18, v18, v31, v31
    v_fma_f32 v19, v19, v31, v31
    v_fma_f32 v20, v20, v31, v31
    v_fma_f32 v21, v21, v31, v31
    v_fma_f32 v22, v22, v31, v31
    v_fma_f32 v23, v23, v31, v31
    v_rcp_f32 v16, v16
    v_rcp_f32 v17, v17
    v_rcp_f32 v18, v18
    v_rcp_f32 v19, v19
    v_rcp_f32 v20, v20
    v_rcp_f32 v21, v21
    v_rcp_f32 v22, v22
    v_rcp_f32 v23, v23
    v_mul_f32 v104, v16, v104
    v_mul_f32 v105, v17, v105
    v_mul_f32 v106, v18, v106
    v_mul_f32 v107, v19, v107
    v_mul_f32 v108, v20, v108
    v_mul_f32 v109, v21, v109
    v_mul_f32 v110, v22, v110
    v_mul_f32 v111, v23, v111
    v_cvt_pk_bf16_f32 v104, v104, v105
    v_cvt_pk_bf16_f32 v105, v106, v107
    v_cvt_pk_bf16_f32 v106, v108, v109
    v_cvt_pk_bf16_f32 v107, v110, v111
    buffer_store_dwordx4 v[104:107], v1, s[56:59], s41 offen offset:1024
    v_mul_f32 v8, v112, v112
    v_mul_f32 v9, v113, v113
    v_mul_f32 v10, v114, v114
    v_mul_f32 v11, v115, v115
    v_mul_f32 v12, v116, v116
    v_mul_f32 v13, v117, v117
    v_mul_f32 v14, v118, v118
    v_mul_f32 v15, v119, v119
    v_fma_f32 v8, v8, v30, v29
    v_fma_f32 v9, v9, v30, v29
    v_fma_f32 v10, v10, v30, v29
    v_fma_f32 v11, v11, v30, v29
    v_fma_f32 v12, v12, v30, v29
    v_fma_f32 v13, v13, v30, v29
    v_fma_f32 v14, v14, v30, v29
    v_fma_f32 v15, v15, v30, v29
    v_mul_f32 v8, v8, v112
    v_mul_f32 v9, v9, v113
    v_mul_f32 v10, v10, v114
    v_mul_f32 v11, v11, v115
    v_mul_f32 v12, v12, v116
    v_mov_b32 v92, 4
    s_waitcnt vmcnt(4)
    buffer_store_dword v92, v28, s[8:11], s43 offen
    v_mul_f32 v13, v13, v117
    v_mul_f32 v14, v14, v118
    v_mul_f32 v15, v15, v119
    v_exp_f32 v8, v8
    v_exp_f32 v9, v9
    v_exp_f32 v10, v10
    v_exp_f32 v11, v11
    v_exp_f32 v12, v12
    v_exp_f32 v13, v13
    v_exp_f32 v14, v14
    v_exp_f32 v15, v15
    v_fma_f32 v8, v8, v31, v31
    v_fma_f32 v9, v9, v31, v31
    v_fma_f32 v10, v10, v31, v31
    v_fma_f32 v11, v11, v31, v31
    v_fma_f32 v12, v12, v31, v31
    v_fma_f32 v13, v13, v31, v31
    v_fma_f32 v14, v14, v31, v31
    v_fma_f32 v15, v15, v31, v31
    v_rcp_f32 v8, v8
    v_rcp_f32 v9, v9
    v_rcp_f32 v10, v10
    v_rcp_f32 v11, v11
    v_rcp_f32 v12, v12
    v_rcp_f32 v13, v13
    v_rcp_f32 v14, v14
    v_rcp_f32 v15, v15
    v_mul_f32 v112, v8, v112
    v_mul_f32 v113, v9, v113
    v_mul_f32 v114, v10, v114
    v_mul_f32 v115, v11, v115
    v_mul_f32 v116, v12, v116
    v_mul_f32 v117, v13, v117
    v_mul_f32 v118, v14, v118
    v_mul_f32 v119, v15, v119
    v_cvt_pk_bf16_f32 v112, v112, v113
    v_cvt_pk_bf16_f32 v113, v114, v115
    v_cvt_pk_bf16_f32 v114, v116, v117
    v_cvt_pk_bf16_f32 v115, v118, v119
    buffer_store_dwordx4 v[112:115], v1, s[56:59], s41 offen offset:2048
    v_mov_b32 v8, 7
    s_mov_b64 exec, 1
    s_cmp_lg_u32 s15, 0
    s_waitcnt vmcnt(0)
    s_cbranch_scc1 mega_kernel_sig19a
    buffer_store_dword v8, off, s[8:11], s43
mega_kernel_sig19b:
    s_mov_b64 exec, -1
    s_setprio 0
    s_cmp_lg_u32 s14, 0
    s_cbranch_scc1 mega_kernel_cfin
    s_mov_b32 s14, 1
    s_mov_b32 s96, 0
    s_add_u32 s8, s8, 0x500000
    s_addc_u32 s9, s9, 0
    s_add_u32 s56, s56, 0x0
    s_addc_u32 s57, s57, 0
    s_mul_i32 s36, s19, 101376
    s_add_u32 s36, s36, 0x0
    v_add_u32 v10, s36, v1
    s_mul_i32 m0, s16, 25600
    s_barrier
    buffer_load_dwordx4 v10, s[4:7], m0 offen offset:0 lds
    buffer_load_dwordx4 v10, s[4:7], m0 offen offset:1024 lds
    buffer_load_dwordx4 v10, s[4:7], m0 offen offset:2048 lds
    buffer_load_dwordx4 v10, s[4:7], m0 offen offset:3072 lds
    s_add_u32 m0, m0, 4096
    s_nop 0
    buffer_load_dwordx4 v10, s[4:7], m0 offen offset:0 lds
    buffer_load_dwordx4 v10, s[4:7], m0 offen offset:1024 lds
    buffer_load_dwordx4 v10, s[4:7], m0 offen offset:2048 lds
    buffer_load_dwordx4 v10, s[4:7], m0 offen offset:3072 lds
    s_barrier
    s_add_u32 m0, m0, 4096
    s_waitcnt vmcnt(5)
    buffer_load_dwordx4 v10, s[4:7], m0 offen offset:0 lds
    s_waitcnt vmcnt(5)
    buffer_load_dwordx4 v10, s[4:7], m0 offen offset:1024 lds
    s_waitcnt vmcnt(5)
    buffer_load_dwordx4 v10, s[4:7], m0 offen offset:2048 lds
    s_waitcnt vmcnt(5)
    buffer_load_dwordx4 v10, s[4:7], m0 offen offset:3072 lds
    s_add_u32 m0, m0, 4096
    s_waitcnt vmcnt(5)
    buffer_load_dwordx4 v10, s[4:7], m0 offen offset:0 lds
    s_waitcnt vmcnt(5)
    buffer_load_dwordx4 v10, s[4:7], m0 offen offset:1024 lds
    s_waitcnt vmcnt(5)
    buffer_load_dwordx4 v10, s[4:7], m0 offen offset:2048 lds
    s_waitcnt vmcnt(5)
    buffer_load_dwordx4 v10, s[4:7], m0 offen offset:3072 lds
    s_add_u32 m0, m0, 4096
    s_waitcnt vmcnt(5)
    buffer_load_dwordx4 v10, s[4:7], m0 offen offset:0 lds
    s_waitcnt vmcnt(5)
    buffer_load_dwordx4 v10, s[4:7], m0 offen offset:1024 lds
    s_waitcnt vmcnt(5)
    buffer_load_dwordx4 v10, s[4:7], m0 offen offset:2048 lds
    s_waitcnt vmcnt(5)
    buffer_load_dwordx4 v10, s[4:7], m0 offen offset:3072 lds
    s_add_u32 m0, m0, 4096
    s_waitcnt vmcnt(5)
    buffer_load_dwordx4 v10, s[4:7], m0 offen offset:0 lds
    s_waitcnt vmcnt(5)
    buffer_load_dwordx4 v10, s[4:7], m0 offen offset:1024 lds
    s_waitcnt vmcnt(5)
    buffer_load_dwordx4 v10, s[4:7], m0 offen offset:2048 lds
    s_waitcnt vmcnt(5)
    buffer_load_dwordx4 v10, s[4:7], m0 offen offset:3072 lds
    s_add_u32 m0, m0, 4096
    s_waitcnt vmcnt(5)
    buffer_load_dwordx4 v10, s[4:7], m0 offen offset:0 lds
    s_branch mega_kernel_qkv_c
mega_kernel_wo_h:
    s_waitcnt vmcnt(6)
    s_barrier
    s_waitcnt vmcnt(4)
    s_barrier
    s_waitcnt vmcnt(2)
    s_barrier
    s_waitcnt vmcnt(0)
    s_barrier
    s_mul_i32 s36, s16, 5120
    s_add_u32 m0, s36, 98304
    s_mul_i32 s40, s16, 10240
    s_add_u32 s40, s40, 122880
    s_mul_i32 s41, s16, 14336
    s_mov_b32 s42, s47
    s_add_u32 s37, s22, 0x0
    s_and_b32 s38, s22, 0x7fff
    s_lshr_b32 s38, s38, 5
    v_lshrrev_b32 v10, 5, v0
    v_lshlrev_b32 v10, 3, v10
    buffer_load_dwordx2 v[24:25], v10, s[24:27], s38 offen offset:0
    buffer_load_dwordx2 v[26:27], v10, s[24:27], s38 offen offset:16
    buffer_load_dwordx2 v[28:29], v10, s[24:27], s38 offen offset:32
    buffer_load_dwordx2 v[30:31], v10, s[24:27], s38 offen offset:48
    s_lshl_b32 s36, s20, 7
    s_lshl_b32 s38, s16, 4
    s_add_u32 s36, s36, s38
    s_add_u32 s36, s36, 0xc000
    s_lshr_b32 s44, s16, 1
    s_xor_b32 s48, s44, 1
    s_add_u32 s44, s44, s20
    s_add_u32 s48, s48, s20
    s_mul_i32 s44, s44, 114688
    s_mul_i32 s48, s48, 114688
    s_mul_i32 s39, s16, 28672
    s_add_u32 s39, s39, 0x240000
    s_add_u32 s44, s44, s39
    s_add_u32 s48, s48, s39
    s_and_b32 s39, s16, 1
    s_lshl_b32 s39, s39, 10
    v_add_u32 v14, s39, v2
    v_xor_b32 v15, 0x400, v14
    v_add_u32 v8, s40, v14
    v_add_u32 v9, s40, v15
    v_add_u32 v12, s41, v14
    v_add_u32 v13, s41, v15
    v_bfe_u32 v10, v0, 2, 1
    v_and_b32 v11, 3, v0
    v_lshlrev_b32 v10, 7, v10
    v_lshl_add_u32 v10, v11, 2, v10
    s_add_u32 s45, s44, 7168
    s_add_u32 s46, s44, 14336
    s_add_u32 s47, s44, 21504
    s_add_u32 s49, s48, 7168
    s_add_u32 s50, s48, 14336
    s_add_u32 s51, s48, 21504
    s_barrier
    buffer_load_dwordx4 v125, s[4:7], m0 offen offset:0 lds
    buffer_load_dwordx4 v125, s[4:7], m0 offen offset:1024 lds
    buffer_load_dwordx4 v125, s[4:7], m0 offen offset:2048 lds
    buffer_load_dwordx4 v125, s[4:7], m0 offen offset:3072 lds
    s_add_u32 m0, m0, 4096
    s_nop 0
    buffer_load_dwordx4 v125, s[4:7], m0 offen offset:0 lds
    s_add_u32 m0, s40, 0
    s_add_u32 s38, s42, 0
    buffer_load_dwordx4 v1, s[4:7], s38 offen offset:0 lds
    buffer_load_dwordx4 v1, s[4:7], s38 offen offset:1024 lds
    s_add_u32 m0, s40, 2048
    s_add_u32 s38, s42, 14336
    buffer_load_dwordx4 v1, s[4:7], s38 offen offset:0 lds
    buffer_load_dwordx4 v1, s[4:7], s38 offen offset:1024 lds
    s_add_u32 m0, s40, 4096
    s_add_u32 s38, s42, 28672
    buffer_load_dwordx4 v1, s[4:7], s38 offen offset:0 lds
    buffer_load_dwordx4 v1, s[4:7], s38 offen offset:1024 lds
    s_add_u32 m0, s40, 6144
    s_add_u32 s38, s42, 43008
    buffer_load_dwordx4 v1, s[4:7], s38 offen offset:0 lds
    buffer_load_dwordx4 v1, s[4:7], s38 offen offset:1024 lds
    s_add_u32 m0, s40, 8192
    s_add_u32 s38, s42, 2048
    buffer_load_dwordx4 v1, s[4:7], s38 offen offset:0 lds
    buffer_load_dwordx4 v1, s[4:7], s38 offen offset:1024 lds
    s_waitcnt vmcnt(10)
    s_barrier
    buffer_load_dwordx4 v[16:19], v1, s[56:59], s37 offen sc1
    buffer_load_dwordx4 v[20:23], v1, s[56:59], s37 offen offset:1024 sc1
    s_add_u32 m0, s41, 0
    s_add_u32 s38, s42, 16384
    buffer_load_dwordx4 v1, s[4:7], s38 offen offset:0 lds
    buffer_load_dwordx4 v1, s[4:7], s38 offen offset:1024 lds
    s_add_u32 m0, s41, 2048
    s_add_u32 s38, s42, 30720
    buffer_load_dwordx4 v1, s[4:7], s38 offen offset:0 lds
    buffer_load_dwordx4 v1, s[4:7], s38 offen offset:1024 lds
    s_add_u32 m0, s41, 4096
    s_add_u32 s38, s42, 45056
    buffer_load_dwordx4 v1, s[4:7], s38 offen offset:0 lds
    buffer_load_dwordx4 v1, s[4:7], s38 offen offset:1024 lds
    s_add_u32 m0, s41, 6144
    s_add_u32 s38, s42, 4096
    buffer_load_dwordx4 v1, s[4:7], s38 offen offset:0 lds
    buffer_load_dwordx4 v1, s[4:7], s38 offen offset:1024 lds
    s_add_u32 m0, s41, 8192
    s_add_u32 s38, s42, 18432
    buffer_load_dwordx4 v1, s[4:7], s38 offen offset:0 lds
    buffer_load_dwordx4 v1, s[4:7], s38 offen offset:1024 lds
    s_add_u32 m0, s41, 10240
    s_add_u32 s38, s42, 32768
    buffer_load_dwordx4 v1, s[4:7], s38 offen offset:0 lds
    buffer_load_dwordx4 v1, s[4:7], s38 offen offset:1024 lds
    s_add_u32 m0, s41, 12288
    s_add_u32 s38, s42, 47104
    buffer_load_dwordx4 v1, s[4:7], s38 offen offset:0 lds
    buffer_load_dwordx4 v1, s[4:7], s38 offen offset:1024 lds
    s_waitcnt vmcnt(14)
    v_lshlrev_b32 v64, 16, v16
    v_and_b32 v65, 0xffff0000, v16
    v_lshlrev_b32 v66, 16, v17
    v_and_b32 v67, 0xffff0000, v17
    v_lshlrev_b32 v68, 16, v18
    v_and_b32 v69, 0xffff0000, v18
    v_lshlrev_b32 v70, 16, v19
    v_and_b32 v71, 0xffff0000, v19
    v_lshlrev_b32 v72, 16, v20
    v_and_b32 v73, 0xffff0000, v20
    v_lshlrev_b32 v74, 16, v21
    v_and_b32 v75, 0xffff0000, v21
    v_lshlrev_b32 v76, 16, v22
    v_and_b32 v77, 0xffff0000, v22
    v_lshlrev_b32 v78, 16, v23
    v_and_b32 v79, 0xffff0000, v23
    v_lshlrev_b32 v14, 16, v24
    v_and_b32 v15, 0xffff0000, v24
    v_add_f32 v64, v64, v14
    v_add_f32 v65, v65, v15
    v_lshlrev_b32 v14, 16, v25
    v_and_b32 v15, 0xffff0000, v25
    v_add_f32 v66, v66, v14
    v_add_f32 v67, v67, v15
    v_lshlrev_b32 v14, 16, v26
    v_and_b32 v15, 0xffff0000, v26
    v_add_f32 v68, v68, v14
    v_add_f32 v69, v69, v15
    v_lshlrev_b32 v14, 16, v27
    v_and_b32 v15, 0xffff0000, v27
    v_add_f32 v70, v70, v14
    v_add_f32 v71, v71, v15
    v_lshlrev_b32 v14, 16, v28
    v_and_b32 v15, 0xffff0000, v28
    v_add_f32 v72, v72, v14
    v_add_f32 v73, v73, v15
    v_lshlrev_b32 v14, 16, v29
    v_and_b32 v15, 0xffff0000, v29
    v_add_f32 v74, v74, v14
    v_add_f32 v75, v75, v15
    v_lshlrev_b32 v14, 16, v30
    v_and_b32 v15, 0xffff0000, v30
    v_add_f32 v76, v76, v14
    v_add_f32 v77, v77, v15
    v_lshlrev_b32 v14, 16, v31
    v_and_b32 v15, 0xffff0000, v31
    v_add_f32 v78, v78, v14
    v_add_f32 v79, v79, v15
    v_add_u32 v14, s40, v1
    s_lshl_b32 s38, s16, 12
    s_add_u32 s38, s38, 106496
    v_add_u32 v15, s38, v1
    s_mov_b32 s35, 0
mega_kernel_poll20:
    buffer_load_dword v11, v10, s[8:11], s36 offen sc1
    s_add_u32 s35, s35, 1
    s_cmp_gt_u32 s35, 20000
    s_cbranch_scc1 mega_kernel_end
    s_waitcnt vmcnt(0)
    v_cmp_gt_u32 vcc, 1, v11
    s_cbranch_vccnz mega_kernel_poll20
mega_kernel_poll20x:
    s_cmp_lg_u32 s15, 0
    s_cbranch_scc1 mega_kernel_poll20a
mega_kernel_poll20b:
    ds_read_b128 v[16:19], v8 offset:0
    ds_read_b128 v[20:23], v9 offset:0
    buffer_load_dwordx4 v[24:27], v1, s[56:59], s48 offen offset:0 sc1
    buffer_load_dwordx4 v[28:31], v1, s[56:59], s44 offen offset:0 sc1
    buffer_load_dword v11, v10, s[8:11], s36 offen sc1
    buffer_load_dwordx4 v[32:35], v1, s[56:59], s49 offen offset:0 sc1
    buffer_load_dwordx4 v[36:39], v1, s[56:59], s45 offen offset:0 sc1
    buffer_load_dwordx4 v[40:43], v1, s[56:59], s50 offen offset:0 sc1
    buffer_load_dwordx4 v[44:47], v1, s[56:59], s46 offen offset:0 sc1
    buffer_load_dwordx4 v[48:51], v1, s[56:59], s51 offen offset:0 sc1
    buffer_load_dwordx4 v[52:55], v1, s[56:59], s47 offen offset:0 sc1
    s_waitcnt vmcnt(8) lgkmcnt(0)
    v_mfma_f32_32x32x16_bf16 v[96:111], v[16:19], v[24:27], 0
    ds_read_b128 v[56:59], v8 offset:2048
    ds_read_b128 v[60:63], v9 offset:2048
    v_mfma_f32_32x32x16_bf16 v[112:127], v[20:23], v[24:27], 0
    s_waitcnt vmcnt(7)
    v_mfma_f32_32x32x16_bf16 v[64:79], v[16:19], v[28:31], v[64:79]
    v_mfma_f32_32x32x16_bf16 v[80:95], v[20:23], v[28:31], 0
    s_waitcnt vmcnt(5) lgkmcnt(0)
    v_mfma_f32_32x32x16_bf16 v[96:111], v[56:59], v[32:35], v[96:111]
    ds_read_b128 v[24:27], v8 offset:4096
    ds_read_b128 v[28:31], v9 offset:4096
    v_mfma_f32_32x32x16_bf16 v[112:127], v[60:63], v[32:35], v[112:127]
    v_cmp_gt_u32 vcc, 2, v11
    s_cbranch_vccnz mega_kernel_gate21
mega_kernel_gate21b:
    buffer_load_dword v11, v10, s[8:11], s36 offen sc1
    buffer_load_dwordx4 v[16:19], v1, s[56:59], s48 offen offset:1024 sc1
    s_waitcnt vmcnt(6)
    v_mfma_f32_32x32x16_bf16 v[64:79], v[56:59], v[36:39], v[64:79]
    v_mfma_f32_32x32x16_bf16 v[80:95], v[60:63], v[36:39], v[80:95]
    buffer_load_dwordx4 v[20:23], v1, s[56:59], s44 offen offset:1024 sc1
    buffer_load_dwordx4 v[32:35], v1, s[56:59], s49 offen offset:1024 sc1
    s_waitcnt vmcnt(7) lgkmcnt(0)
    v_mfma_f32_32x32x16_bf16 v[96:111], v[24:27], v[40:43], v[96:111]
    ds_read_b128 v[36:39], v8 offset:6144
    ds_read_b128 v[56:59], v9 offset:6144
    v_mfma_f32_32x32x16_bf16 v[112:127], v[28:31], v[40:43], v[112:127]
    s_waitcnt vmcnt(6)
    v_mfma_f32_32x32x16_bf16 v[64:79], v[24:27], v[44:47], v[64:79]
    v_mfma_f32_32x32x16_bf16 v[80:95], v[28:31], v[44:47], v[80:95]
    buffer_load_dwordx4 v[60:63], v1, s[56:59], s45 offen offset:1024 sc1
    buffer_load_dwordx4 v[40:43], v1, s[56:59], s50 offen offset:1024 sc1
    s_waitcnt vmcnt(7) lgkmcnt(0)
    v_mfma_f32_32x32x16_bf16 v[96:111], v[36:39], v[48:51], v[96:111]
    ds_read_b128 v[44:47], v8 offset:8192
    ds_read_b128 v[24:27], v9 offset:8192
    v_mfma_f32_32x32x16_bf16 v[112:127], v[56:59], v[48:51], v[112:127]
    s_waitcnt vmcnt(6)
    v_mfma_f32_32x32x16_bf16 v[64:79], v[36:39], v[52:55], v[64:79]
    v_mfma_f32_32x32x16_bf16 v[80:95], v[56:59], v[52:55], v[80:95]
    buffer_load_dwordx4 v[28:31], v1, s[56:59], s46 offen offset:1024 sc1
    buffer_load_dwordx4 v[48:51], v1, s[56:59], s51 offen offset:1024 sc1
    s_waitcnt vmcnt(6) lgkmcnt(0)
    v_mfma_f32_32x32x16_bf16 v[96:111], v[44:47], v[16:19], v[96:111]
    ds_read_b128 v[52:55], v12 offset:0
    ds_read_b128 v[36:39], v13 offset:0
    v_mfma_f32_32x32x16_bf16 v[112:127], v[24:27], v[16:19], v[112:127]
    s_waitcnt vmcnt(5)
    v_mfma_f32_32x32x16_bf16 v[64:79], v[44:47], v[20:23], v[64:79]
    v_mfma_f32_32x32x16_bf16 v[80:95], v[24:27], v[20:23], v[80:95]
    buffer_load_dwordx4 v[56:59], v1, s[56:59], s47 offen offset:1024 sc1
    v_cmp_gt_u32 vcc, 3, v11
    s_cbranch_vccnz mega_kernel_gate22
mega_kernel_gate22b:
    buffer_load_dword v11, v10, s[8:11], s36 offen sc1
    buffer_load_dwordx4 v[16:19], v1, s[56:59], s48 offen offset:2048 sc1
    s_waitcnt vmcnt(7) lgkmcnt(0)
    v_mfma_f32_32x32x16_bf16 v[96:111], v[52:55], v[32:35], v[96:111]
    ds_read_b128 v[20:23], v12 offset:2048
    ds_read_b128 v[44:47], v13 offset:2048
    v_mfma_f32_32x32x16_bf16 v[112:127], v[36:39], v[32:35], v[112:127]
    s_waitcnt vmcnt(6)
    v_mfma_f32_32x32x16_bf16 v[64:79], v[52:55], v[60:63], v[64:79]
    v_mfma_f32_32x32x16_bf16 v[80:95], v[36:39], v[60:63], v[80:95]
    buffer_load_dwordx4 v[24:27], v1, s[56:59], s44 offen offset:2048 sc1
    buffer_load_dwordx4 v[32:35], v1, s[56:59], s49 offen offset:2048 sc1
    s_waitcnt vmcnt(7) lgkmcnt(0)
    v_mfma_f32_32x32x16_bf16 v[96:111], v[20:23], v[40:43], v[96:111]
    ds_read_b128 v[60:63], v12 offset:4096
    ds_read_b128 v[52:55], v13 offset:4096
    v_mfma_f32_32x32x16_bf16 v[112:127], v[44:47], v[40:43], v[112:127]
    s_waitcnt vmcnt(6)
    v_mfma_f32_32x32x16_bf16 v[64:79], v[20:23], v[28:31], v[64:79]
    v_mfma_f32_32x32x16_bf16 v[80:95], v[44:47], v[28:31], v[80:95]
    buffer_load_dwordx4 v[36:39], v1, s[56:59], s45 offen offset:2048 sc1
    buffer_load_dwordx4 v[40:43], v1, s[56:59], s50 offen offset:2048 sc1
    s_waitcnt vmcnt(7) lgkmcnt(0)
    v_mfma_f32_32x32x16_bf16 v[96:111], v[60:63], v[48:51], v[96:111]
    ds_read_b128 v[28:31], v12 offset:6144
    ds_read_b128 v[20:23], v13 offset:6144
    v_mfma_f32_32x32x16_bf16 v[112:127], v[52:55], v[48:51], v[112:127]
    s_waitcnt vmcnt(6)
    v_mfma_f32_32x32x16_bf16 v[64:79], v[60:63], v[56:59], v[64:79]
    v_mfma_f32_32x32x16_bf16 v[80:95], v[52:55], v[56:59], v[80:95]
    buffer_load_dwordx4 v[44:47], v1, s[56:59], s46 offen offset:2048 sc1
    buffer_load_dwordx4 v[48:51], v1, s[56:59], s51 offen offset:2048 sc1
    s_waitcnt vmcnt(6) lgkmcnt(0)
    v_mfma_f32_32x32x16_bf16 v[96:111], v[28:31], v[16:19], v[96:111]
    ds_read_b128 v[56:59], v12 offset:8192
    ds_read_b128 v[60:63], v13 offset:8192
    v_mfma_f32_32x32x16_bf16 v[112:127], v[20:23], v[16:19], v[112:127]
    s_waitcnt vmcnt(5)
    v_mfma_f32_32x32x16_bf16 v[64:79], v[28:31], v[24:27], v[64:79]
    v_mfma_f32_32x32x16_bf16 v[80:95], v[20:23], v[24:27], v[80:95]
    buffer_load_dwordx4 v[52:55], v1, s[56:59], s47 offen offset:2048 sc1
    v_cmp_gt_u32 vcc, 4, v11
    s_cbranch_vccnz mega_kernel_gate23
mega_kernel_gate23b:
    buffer_load_dword v11, v10, s[8:11], s36 offen sc1
    buffer_load_dwordx4 v[16:19], v1, s[56:59], s48 offen offset:3072 sc1
    s_waitcnt vmcnt(7) lgkmcnt(0)
    v_mfma_f32_32x32x16_bf16 v[96:111], v[56:59], v[32:35], v[96:111]
    ds_read_b128 v[24:27], v12 offset:10240
    ds_read_b128 v[28:31], v13 offset:10240
    v_mfma_f32_32x32x16_bf16 v[112:127], v[60:63], v[32:35], v[112:127]
    s_waitcnt vmcnt(6)
    v_mfma_f32_32x32x16_bf16 v[64:79], v[56:59], v[36:39], v[64:79]
    v_mfma_f32_32x32x16_bf16 v[80:95], v[60:63], v[36:39], v[80:95]
    buffer_load_dwordx4 v[20:23], v1, s[56:59], s44 offen offset:3072 sc1
    buffer_load_dwordx4 v[32:35], v1, s[56:59], s49 offen offset:3072 sc1
    s_waitcnt vmcnt(7) lgkmcnt(0)
    v_mfma_f32_32x32x16_bf16 v[96:111], v[24:27], v[40:43], v[96:111]
    ds_read_b128 v[36:39], v12 offset:12288
    ds_read_b128 v[56:59], v13 offset:12288
    buffer_load_dwordx4 v[60:63], v1, s[56:59], s45 offen offset:3072 sc1
    v_mfma_f32_32x32x16_bf16 v[112:127], v[28:31], v[40:43], v[112:127]
    buffer_load_dwordx4 v[40:43], v1, s[56:59], s50 offen offset:3072 sc1
    s_waitcnt vmcnt(8)
    v_mfma_f32_32x32x16_bf16 v[64:79], v[24:27], v[44:47], v[64:79]
    v_mfma_f32_32x32x16_bf16 v[80:95], v[28:31], v[44:47], v[80:95]
    buffer_load_dwordx4 v[44:47], v1, s[56:59], s46 offen offset:3072 sc1
    buffer_load_dwordx4 v[24:27], v1, s[56:59], s51 offen offset:3072 sc1
    s_waitcnt vmcnt(9) lgkmcnt(0)
    v_mfma_f32_32x32x16_bf16 v[96:111], v[36:39], v[48:51], v[96:111]
    buffer_load_dwordx4 v[28:31], v1, s[56:59], s47 offen offset:3072 sc1
    v_mfma_f32_32x32x16_bf16 v[112:127], v[56:59], v[48:51], v[112:127]
    s_waitcnt vmcnt(9)
    v_mfma_f32_32x32x16_bf16 v[64:79], v[36:39], v[52:55], v[64:79]
    v_mfma_f32_32x32x16_bf16 v[80:95], v[56:59], v[52:55], v[80:95]
    s_waitcnt vmcnt(7)
    v_mfma_f32_32x32x16_bf16 v[96:111], v[128:131], v[16:19], v[96:111]
    v_cmp_gt_u32 vcc, 5, v11
    s_cbranch_vccnz mega_kernel_gate24
mega_kernel_gate24b:
    buffer_load_dword v11, v10, s[8:11], s36 offen sc1
    s_add_u32 s48, s48, 4096
    buffer_load_dwordx4 v[48:51], v1, s[56:59], s48 offen offset:0 sc1
    s_add_u32 s44, s44, 4096
    buffer_load_dwordx4 v[52:55], v1, s[56:59], s44 offen offset:0 sc1
    v_mfma_f32_32x32x16_bf16 v[112:127], v[132:135], v[16:19], v[112:127]
    s_add_u32 s49, s49, 4096
    buffer_load_dwordx4 v[36:39], v1, s[56:59], s49 offen offset:0 sc1
    s_add_u32 s45, s45, 4096
    buffer_load_dwordx4 v[56:59], v1, s[56:59], s45 offen offset:0 sc1
    s_waitcnt vmcnt(11)
    v_mfma_f32_32x32x16_bf16 v[64:79], v[128:131], v[20:23], v[64:79]
    s_add_u32 s50, s50, 4096
    buffer_load_dwordx4 v[16:19], v1, s[56:59], s50 offen offset:0 sc1
    v_mfma_f32_32x32x16_bf16 v[80:95], v[132:135], v[20:23], v[80:95]
    s_add_u32 s46, s46, 4096
    buffer_load_dwordx4 v[20:23], v1, s[56:59], s46 offen offset:0 sc1
    s_add_u32 s51, s51, 4096
    buffer_load_dwordx4 v[128:131], v1, s[56:59], s51 offen offset:0 sc1
    s_waitcnt vmcnt(13)
    v_mfma_f32_32x32x16_bf16 v[96:111], v[160:163], v[32:35], v[96:111]
    s_add_u32 s47, s47, 4096
    buffer_load_dwordx4 v[132:135], v1, s[56:59], s47 offen offset:0 sc1
    v_mfma_f32_32x32x16_bf16 v[112:127], v[164:167], v[32:35], v[112:127]
    s_waitcnt vmcnt(13)
    v_mfma_f32_32x32x16_bf16 v[64:79], v[160:163], v[60:63], v[64:79]
    v_mfma_f32_32x32x16_bf16 v[80:95], v[164:167], v[60:63], v[80:95]
    s_waitcnt vmcnt(12)
    v_mfma_f32_32x32x16_bf16 v[96:111], v[192:195], v[40:43], v[96:111]
    v_mfma_f32_32x32x16_bf16 v[112:127], v[196:199], v[40:43], v[112:127]
    s_waitcnt vmcnt(11)
    v_mfma_f32_32x32x16_bf16 v[64:79], v[192:195], v[44:47], v[64:79]
    v_mfma_f32_32x32x16_bf16 v[80:95], v[196:199], v[44:47], v[80:95]
    s_waitcnt vmcnt(10)
    v_mfma_f32_32x32x16_bf16 v[96:111], v[224:227], v[24:27], v[96:111]
    v_mfma_f32_32x32x16_bf16 v[112:127], v[228:231], v[24:27], v[112:127]
    s_waitcnt vmcnt(9)
    v_mfma_f32_32x32x16_bf16 v[64:79], v[224:227], v[28:31], v[64:79]
    v_mfma_f32_32x32x16_bf16 v[80:95], v[228:231], v[28:31], v[80:95]
    s_waitcnt vmcnt(7)
    v_mfma_f32_32x32x16_bf16 v[96:111], v[136:139], v[48:51], v[96:111]
    v_cmp_gt_u32 vcc, 6, v11
    s_cbranch_vccnz mega_kernel_gate25
mega_kernel_gate25b:
    buffer_load_dword v11, v10, s[8:11], s36 offen sc1
    buffer_load_dwordx4 v[32:35], v1, s[56:59], s48 offen offset:1024 sc1
    buffer_load_dwordx4 v[60:63], v1, s[56:59], s44 offen offset:1024 sc1
    v_mfma_f32_32x32x16_bf16 v[112:127], v[140:143], v[48:51], v[112:127]
    buffer_load_dwordx4 v[160:163], v1, s[56:59], s49 offen offset:1024 sc1
    buffer_load_dwordx4 v[164:167], v1, s[56:59], s45 offen offset:1024 sc1
    s_waitcnt vmcnt(11)
    v_mfma_f32_32x32x16_bf16 v[64:79], v[136:139], v[52:55], v[64:79]
    buffer_load_dwordx4 v[40:43], v1, s[56:59], s50 offen offset:1024 sc1
    buffer_load_dwordx4 v[44:47], v1, s[56:59], s46 offen offset:1024 sc1
    v_mfma_f32_32x32x16_bf16 v[80:95], v[140:143], v[52:55], v[80:95]
    buffer_load_dwordx4 v[192:195], v1, s[56:59], s51 offen offset:1024 sc1
    buffer_load_dwordx4 v[196:199], v1, s[56:59], s47 offen offset:1024 sc1
    s_waitcnt vmcnt(14)
    v_mfma_f32_32x32x16_bf16 v[96:111], v[168:171], v[36:39], v[96:111]
    v_mfma_f32_32x32x16_bf16 v[112:127], v[172:175], v[36:39], v[112:127]
    s_waitcnt vmcnt(13)
    v_mfma_f32_32x32x16_bf16 v[64:79], v[168:171], v[56:59], v[64:79]
    v_mfma_f32_32x32x16_bf16 v[80:95], v[172:175], v[56:59], v[80:95]
    s_waitcnt vmcnt(12)
    v_mfma_f32_32x32x16_bf16 v[96:111], v[200:203], v[16:19], v[96:111]
    v_mfma_f32_32x32x16_bf16 v[112:127], v[204:207], v[16:19], v[112:127]
    s_waitcnt vmcnt(11)
    v_mfma_f32_32x32x16_bf16 v[64:79], v[200:203], v[20:23], v[64:79]
    v_mfma_f32_32x32x16_bf16 v[80:95], v[204:207], v[20:23], v[80:95]
    s_waitcnt vmcnt(10)
    v_mfma_f32_32x32x16_bf16 v[96:111], v[232:235], v[128:131], v[96:111]
    v_mfma_f32_32x32x16_bf16 v[112:127], v[236:239], v[128:131], v[112:127]
    s_waitcnt vmcnt(9)
    v_mfma_f32_32x32x16_bf16 v[64:79], v[232:235], v[132:135], v[64:79]
    v_mfma_f32_32x32x16_bf16 v[80:95], v[236:239], v[132:135], v[80:95]
    s_waitcnt vmcnt(7)
    v_mfma_f32_32x32x16_bf16 v[96:111], v[144:147], v[32:35], v[96:111]
    v_cmp_gt_u32 vcc, 7, v11
    s_cbranch_vccnz mega_kernel_gate26
mega_kernel_gate26b:
    buffer_load_dwordx4 v[24:27], v1, s[56:59], s48 offen offset:2048 sc1
    buffer_load_dwordx4 v[28:31], v1, s[56:59], s49 offen offset:2048 sc1
    v_mfma_f32_32x32x16_bf16 v[112:127], v[148:151], v[32:35], v[112:127]
    buffer_load_dwordx4 v[224:227], v1, s[56:59], s50 offen offset:2048 sc1
    buffer_load_dwordx4 v[228:231], v1, s[56:59], s51 offen offset:2048 sc1
    s_waitcnt vmcnt(10)
    v_mfma_f32_32x32x16_bf16 v[64:79], v[144:147], v[60:63], v[64:79]
    buffer_load_dwordx4 v[48:51], v1, s[56:59], s44 offen offset:2048 sc1
    buffer_load_dwordx4 v[52:55], v1, s[56:59], s45 offen offset:2048 sc1
    v_mfma_f32_32x32x16_bf16 v[80:95], v[148:151], v[60:63], v[80:95]
    buffer_load_dwordx4 v[136:139], v1, s[56:59], s46 offen offset:2048 sc1
    buffer_load_dwordx4 v[140:143], v1, s[56:59], s47 offen offset:2048 sc1
    s_barrier
    s_waitcnt vmcnt(13)
    v_mfma_f32_32x32x16_bf16 v[96:111], v[176:179], v[160:163], v[96:111]
    v_mfma_f32_32x32x16_bf16 v[112:127], v[180:183], v[160:163], v[112:127]
    s_waitcnt vmcnt(12)
    v_mfma_f32_32x32x16_bf16 v[64:79], v[176:179], v[164:167], v[64:79]
    v_mfma_f32_32x32x16_bf16 v[80:95], v[180:183], v[164:167], v[80:95]
    s_waitcnt vmcnt(11)
    v_mfma_f32_32x32x16_bf16 v[96:111], v[208:211], v[40:43], v[96:111]
    v_mfma_f32_32x32x16_bf16 v[112:127], v[212:215], v[40:43], v[112:127]
    s_waitcnt vmcnt(10)
    v_mfma_f32_32x32x16_bf16 v[64:79], v[208:211], v[44:47], v[64:79]
    v_mfma_f32_32x32x16_bf16 v[80:95], v[212:215], v[44:47], v[80:95]
    s_waitcnt vmcnt(9)
    v_mfma_f32_32x32x16_bf16 v[96:111], v[240:243], v[192:195], v[96:111]
    v_mfma_f32_32x32x16_bf16 v[112:127], v[244:247], v[192:195], v[112:127]
    s_waitcnt vmcnt(8)
    v_mfma_f32_32x32x16_bf16 v[64:79], v[240:243], v[196:199], v[64:79]
    v_mfma_f32_32x32x16_bf16 v[80:95], v[244:247], v[196:199], v[80:95]
    s_waitcnt vmcnt(7)
    v_mfma_f32_32x32x16_bf16 v[96:111], v[152:155], v[24:27], v[96:111]
    v_mfma_f32_32x32x16_bf16 v[112:127], v[156:159], v[24:27], v[112:127]
    s_waitcnt vmcnt(6)
    v_mfma_f32_32x32x16_bf16 v[96:111], v[184:187], v[28:31], v[96:111]
    v_mfma_f32_32x32x16_bf16 v[112:127], v[188:191], v[28:31], v[112:127]
    s_waitcnt vmcnt(5)
    v_mfma_f32_32x32x16_bf16 v[96:111], v[216:219], v[224:227], v[96:111]
    v_mfma_f32_32x32x16_bf16 v[112:127], v[220:223], v[224:227], v[112:127]
    s_waitcnt vmcnt(4)
    v_mfma_f32_32x32x16_bf16 v[96:111], v[248:251], v[228:231], v[96:111]
    v_mfma_f32_32x32x16_bf16 v[112:127], v[252:255], v[228:231], v[112:127]
    s_xor_b32 s36, s16, 1
    s_mul_i32 s36, s36, 4096
    s_add_u32 s36, s36, 106496
    v_add_u32 v37, s36, v1
    s_xor_b32 s36, s16, 2
    s_mul_i32 s36, s36, 10240
    s_add_u32 s36, s36, 122880
    v_add_u32 v38, s36, v1
    s_xor_b32 s36, s16, 3
    s_mul_i32 s36, s36, 10240
    s_add_u32 s36, s36, 126976
    v_add_u32 v39, s36, v1
    s_waitcnt vmcnt(3)
    v_mfma_f32_32x32x16_bf16 v[80:95], v[156:159], v[48:51], v[80:95]
    s_waitcnt vmcnt(2)
    v_mfma_f32_32x32x16_bf16 v[80:95], v[188:191], v[52:55], v[80:95]
    ds_write_b128 v14, v[96:99] offset:0
    ds_write_b128 v14, v[100:103] offset:1024
    v_mfma_f32_32x32x16_bf16 v[64:79], v[152:155], v[48:51], v[64:79]
    ds_write_b128 v14, v[104:107] offset:2048
    ds_write_b128 v14, v[108:111] offset:3072
    s_waitcnt vmcnt(1)
    v_mfma_f32_32x32x16_bf16 v[80:95], v[220:223], v[136:139], v[80:95]
    ds_write_b128 v14, v[112:115] offset:4096
    ds_write_b128 v14, v[116:119] offset:5120
    v_mfma_f32_32x32x16_bf16 v[64:79], v[184:187], v[52:55], v[64:79]
    ds_write_b128 v14, v[120:123] offset:6144
    ds_write_b128 v14, v[124:127] offset:7168
    s_waitcnt vmcnt(0)
    v_mfma_f32_32x32x16_bf16 v[80:95], v[252:255], v[140:143], v[80:95]
    v_mfma_f32_32x32x16_bf16 v[64:79], v[216:219], v[136:139], v[64:79]
    s_nop 7
    s_nop 2
    ds_write_b128 v15, v[80:83] offset:0
    v_mfma_f32_32x32x16_bf16 v[64:79], v[248:251], v[140:143], v[64:79]
    ds_write_b128 v15, v[84:87] offset:1024
    ds_write_b128 v15, v[88:91] offset:2048
    ds_write_b128 v15, v[92:95] offset:3072
    s_waitcnt lgkmcnt(0)
    s_barrier
    ds_read_b128 v[112:115], v39 offset:0
    ds_read_b128 v[116:119], v39 offset:1024
    ds_read_b128 v[120:123], v39 offset:2048
    ds_read_b128 v[124:127], v39 offset:3072
    ds_read_b128 v[96:99], v38 offset:0
    ds_read_b128 v[100:103], v38 offset:1024
    ds_read_b128 v[104:107], v38 offset:2048
    ds_read_b128 v[108:111], v38 offset:3072
    ds_read_b128 v[80:83], v37 offset:0
    ds_read_b128 v[84:87], v37 offset:1024
    ds_read_b128 v[88:91], v37 offset:2048
    ds_read_b128 v[92:95], v37 offset:3072
    s_waitcnt lgkmcnt(8)
    v_pk_add_f32 v[64:65], v[64:65], v[112:113]
    v_pk_add_f32 v[66:67], v[66:67], v[114:115]
    v_pk_add_f32 v[68:69], v[68:69], v[116:117]
    v_pk_add_f32 v[70:71], v[70:71], v[118:119]
    v_pk_add_f32 v[72:73], v[72:73], v[120:121]
    v_pk_add_f32 v[74:75], v[74:75], v[122:123]
    v_pk_add_f32 v[76:77], v[76:77], v[124:125]
    v_pk_add_f32 v[78:79], v[78:79], v[126:127]
    s_waitcnt lgkmcnt(4)
    v_pk_add_f32 v[64:65], v[64:65], v[96:97]
    v_pk_add_f32 v[66:67], v[66:67], v[98:99]
    v_pk_add_f32 v[68:69], v[68:69], v[100:101]
    v_pk_add_f32 v[70:71], v[70:71], v[102:103]
    v_pk_add_f32 v[72:73], v[72:73], v[104:105]
    v_pk_add_f32 v[74:75], v[74:75], v[106:107]
    v_pk_add_f32 v[76:77], v[76:77], v[108:109]
    v_pk_add_f32 v[78:79], v[78:79], v[110:111]
    s_waitcnt lgkmcnt(0)
    v_pk_add_f32 v[64:65], v[64:65], v[80:81]
    v_pk_add_f32 v[66:67], v[66:67], v[82:83]
    v_pk_add_f32 v[68:69], v[68:69], v[84:85]
    v_pk_add_f32 v[70:71], v[70:71], v[86:87]
    v_pk_add_f32 v[72:73], v[72:73], v[88:89]
    v_pk_add_f32 v[74:75], v[74:75], v[90:91]
    v_pk_add_f32 v[76:77], v[76:77], v[92:93]
    v_pk_add_f32 v[78:79], v[78:79], v[94:95]
    s_cmp_lg_u32 s14, 0
    s_cbranch_scc1 mega_kernel_final
    s_add_u32 s36, s22, 0x0
    s_add_u32 s37, s23, 0x200000
    s_add_u32 s38, s32, 0x500000
    v_cvt_pk_bf16_f32 v64, v64, v65
    v_cvt_pk_bf16_f32 v65, v66, v67
    v_cvt_pk_bf16_f32 v66, v68, v69
    v_cvt_pk_bf16_f32 v67, v70, v71
    buffer_store_dwordx4 v[64:67], v1, s[56:59], s36 offen offset:0
    v_cvt_pk_bf16_f32 v72, v72, v73
    v_cvt_pk_bf16_f32 v73, v74, v75
    v_cvt_pk_bf16_f32 v74, v76, v77
    v_cvt_pk_bf16_f32 v75, v78, v79
    buffer_store_dwordx4 v[72:75], v1, s[56:59], s36 offen offset:1024
    v_dot2_f32_bf16 v8, v64, v6, 0
    v_dot2_f32_bf16 v9, v64, v64, 0
    v_dot2_f32_bf16 v8, v65, v6, v8
    v_dot2_f32_bf16 v9, v65, v65, v9
    v_dot2_f32_bf16 v8, v66, v6, v8
    v_dot2_f32_bf16 v9, v66, v66, v9
    v_dot2_f32_bf16 v8, v67, v6, v8
    v_dot2_f32_bf16 v9, v67, v67, v9
    v_dot2_f32_bf16 v8, v72, v6, v8
    v_dot2_f32_bf16 v9, v72, v72, v9
    v_dot2_f32_bf16 v8, v73, v6, v8
    v_dot2_f32_bf16 v9, v73, v73, v9
    v_dot2_f32_bf16 v8, v74, v6, v8
    v_dot2_f32_bf16 v9, v74, v74, v9
    v_dot2_f32_bf16 v8, v75, v6, v8
    v_dot2_f32_bf16 v9, v75, v75, v9
    s_nop 2
    v_permlane32_swap_b32 v8, v9
    v_add_f32 v8, v8, v9
    buffer_store_dword v8, v5, s[56:59], s37 offen
    v_mov_b32 v10, 1
    s_mov_b64 exec, 1
    s_cmp_lg_u32 s15, 0
    s_waitcnt vmcnt(0)
    s_cbranch_scc1 mega_kernel_sig27a
    buffer_store_dword v10, off, s[8:11], s38
mega_kernel_sig27b:
    s_mov_b64 exec, -1
    s_mov_b32 s14, 1
    s_mov_b32 s96, 0
    s_add_u32 s8, s8, 0x500000
    s_addc_u32 s9, s9, 0
    s_add_u32 s56, s56, 0x0
    s_addc_u32 s57, s57, 0
    s_branch mega_kernel_qkv_h
mega_kernel_final:
    v_cvt_pk_bf16_f32 v16, v64, v65
    v_cvt_pk_bf16_f32 v17, v66, v67
    v_cvt_pk_bf16_f32 v18, v68, v69
    v_cvt_pk_bf16_f32 v19, v70, v71
    v_cvt_pk_bf16_f32 v20, v72, v73
    v_cvt_pk_bf16_f32 v21, v74, v75
    v_cvt_pk_bf16_f32 v22, v76, v77
    v_cvt_pk_bf16_f32 v23, v78, v79
    s_and_b32 s36, s22, 0x7fff
    s_sub_u32 s37, s22, s36
    s_lshr_b32 s36, s36, 5
    s_add_u32 s36, s36, s37
    v_and_b32 v8, 31, v0
    v_lshrrev_b32 v9, 5, v0
    v_lshlrev_b32 v8, 10, v8
    v_lshl_add_u32 v8, v9, 4, v8
    v_permlane32_swap_b32 v16, v18
    v_permlane32_swap_b32 v17, v19
    v_permlane32_swap_b32 v20, v22
    v_permlane32_swap_b32 v21, v23
    buffer_store_dwordx4 v[16:19], v8, s[28:31], s36 offen nt
    buffer_store_dwordx4 v[20:23], v8, s[28:31], s36 offen offset:32 nt
mega_kernel_end:
    s_endpgm
mega_kernel_cfin:
    s_or_b32 s36, s3, s13
    s_cmp_lg_u32 s36, 0
    s_cbranch_scc1 mega_kernel_end
    s_barrier
    buffer_wbl2 sc1
    s_barrier
    s_endpgm
mega_kernel_lead:
    v_mov_b32 v32, 0
    v_mov_b32 v33, 0
    v_mov_b32 v34, 0
    v_mov_b32 v35, 0
    s_lshl_b32 s36, s60, 12
    buffer_store_dwordx4 v[32:35], v1, s[8:11], s36 offen offset:0 sc1
    buffer_store_dwordx4 v[32:35], v1, s[8:11], s36 offen offset:1024 sc1
    buffer_store_dwordx4 v[32:35], v1, s[8:11], s36 offen offset:2048 sc1
    buffer_store_dwordx4 v[32:35], v1, s[8:11], s36 offen offset:3072 sc1
    s_lshl_b32 s36, s60, 2
    s_mov_b64 exec, 0xff
    v_lshl_add_u32 v14, v0, 7, s36
    s_mov_b64 exec, -1
    s_branch mega_kernel_led
mega_kernel_achk:
    s_waitcnt vmcnt(1)
    v_cmp_eq_u32 vcc, v16, v27
    s_and_b32 s36, vcc_lo, 0xff
    s_cbranch_scc0 mega_kernel_achkd
    s_waitcnt vmcnt(0)
    s_mov_b32 s35, 0
    s_sub_u32 s36, s60, 1
    s_cmp_lt_u32 s36, 7
    s_cselect_b64 exec, 0xff, 0
    s_lshl_b32 s36, s60, 2
    v_lshl_add_u32 v14, v0, 7, s36
    s_mov_b64 exec, -1
mega_kernel_achk2:
    v_cmp_eq_u32 vcc, v16, v28
    s_and_b32 s36, vcc_lo, 0xff
    s_cbranch_scc0 mega_kernel_achkd
    buffer_load_dword v28, v13, s[8:11], 0 offen sc1
    buffer_atomic_add v19, v14, s[8:11], 0 offen sc1
    s_add_u32 s35, s35, 1
    s_cmp_gt_u32 s35, 20000
    s_cbranch_scc1 mega_kernel_end
    s_waitcnt vmcnt(0)
    s_branch mega_kernel_achk2
mega_kernel_sig10a:
    buffer_wbl2 sc1
    s_waitcnt vmcnt(0)
    buffer_store_dword v8, off, s[8:11], s43 sc1
    s_branch mega_kernel_sig10b
mega_kernel_poll12a:
    buffer_inv sc1
    s_waitcnt vmcnt(0)
    s_branch mega_kernel_poll12b
mega_kernel_sig13a:
    buffer_wbl2 sc1
    s_waitcnt vmcnt(0)
    buffer_store_dword v8, off, s[8:11], s43 sc1
    s_branch mega_kernel_sig13b
mega_kernel_poll14s:
    s_mov_b64 exec, 1
    v_mov_b32 v132, 1
    s_lshl_b32 s34, s12, 5
    s_add_u32 s34, s34, s13
    s_lshl_b32 s34, s34, 2
    s_add_u32 s34, s34, 0x1800
    s_mov_b64 exec, -1
    v_mov_b32 v132, 1
    v_lshrrev_b32 v133, 3, v0
    v_and_b32 v134, 7, v0
    v_lshlrev_b32 v134, 2, v134
    v_lshl_add_u32 v133, v133, 7, v134
    buffer_atomic_add v132, v133, s[8:11], 0 offen sc1
    s_mov_b64 exec, 1
    s_cmp_lg_u32 s3, 7
    s_cbranch_scc1 mega_kernel_poll14t
    buffer_store_dword v132, off, s[8:11], s34 sc1
    s_or_b32 s34, s98, 0x80
    v_mov_b32 v133, s34
    s_lshl_b32 s34, s2, 2
    s_add_u32 s34, s34, 0x1400
    s_waitcnt vmcnt(0)
    buffer_store_dword v133, off, s[8:11], s34 sc1
mega_kernel_poll14t:
    s_mov_b64 exec, -1
    s_movk_i32 s34, 0x1400
    buffer_load_dwordx4 v[132:135], v1, s[8:11], s34 offen sc1
    s_waitcnt vmcnt(0)
    buffer_load_dwordx4 v[136:139], v1, s[8:11], s34 offen offset:1024 sc1
    v_and_b32 v132, v132, v133
    v_and_b32 v134, v134, v135
    v_and_b32 v132, v132, v134
    v_cmp_gt_u32 vcc, 0x80, v132
    s_waitcnt vmcnt(0)
    s_cbranch_vccnz mega_kernel_poll14
    v_and_b32 v136, v136, v137
    v_and_b32 v138, v138, v139
    v_and_b32 v136, v136, v138
    v_cmp_ne_u32 vcc, 1, v136
    s_cbranch_vccz mega_kernel_poll14
    s_mov_b32 s97, 1
    s_branch mega_kernel_poll14x
mega_kernel_poll14a:
    buffer_inv sc1
    s_waitcnt vmcnt(0)
    s_branch mega_kernel_poll14b
mega_kernel_fwr:
    s_lshl_b32 s36, s12, 5
    s_add_u32 s36, s36, s13
    s_lshr_b32 s37, s36, 6
    s_and_b32 s36, s36, 63
    s_lshl_b32 s36, s36, 5
    s_add_u32 s36, s36, s37
    s_lshl_b32 s36, s36, 2
    s_add_u32 s36, s36, 0x6040
    v_mov_b32 v132, 1
    s_mov_b64 exec, 1
    buffer_store_dword v132, off, s[8:11], s36 sc1
    s_mov_b64 exec, -1
    s_branch mega_kernel_fwrd
mega_kernel_fwl:
    s_movk_i32 s36, 0x6040
    v_lshlrev_b32 v200, 7, v0
    buffer_load_dwordx4 v[128:131], v200, s[8:11], s36 offen sc1
    s_branch mega_kernel_fwld
mega_kernel_fwc:
    s_cmp_lg_u32 s97, 0
    s_waitcnt vmcnt(0)
    s_cbranch_scc1 mega_kernel_fwc2
    v_and_b32 v128, v128, v129
    v_and_b32 v130, v130, v131
    v_and_b32 v128, v128, v130
    v_cmp_ne_u32 vcc, 1, v128
    s_movk_i32 s36, 0x6040
    v_lshlrev_b32 v200, 7, v0
    s_cbranch_vccz mega_kernel_fwc2
    s_mov_b32 s35, 0
mega_kernel_poll28:
    buffer_load_dwordx4 v[128:131], v200, s[8:11], s36 offen sc1
    s_add_u32 s35, s35, 1
    s_cmp_gt_u32 s35, 20000
    s_cbranch_scc1 mega_kernel_end
    s_and_b32 s34, s35, s96
    s_cmp_eq_u32 s34, 63
    s_cbranch_scc1 mega_kernel_poll28s
    s_waitcnt vmcnt(0)
    v_and_b32 v128, v128, v129
    v_and_b32 v130, v130, v131
    v_and_b32 v128, v128, v130
    v_cmp_ne_u32 vcc, 1, v128
    s_cbranch_vccnz mega_kernel_poll28
mega_kernel_poll28x:
mega_kernel_fwc2:
    v_mov_b32 v128, 147456
    v_mov_b32 v129, s97
    ds_write_b32 v128, v129
    s_waitcnt lgkmcnt(0)
    s_branch mega_kernel_fwcd
mega_kernel_fwv:
    v_mov_b32 v128, 147456
    ds_read_b32 v128, v128
    s_waitcnt lgkmcnt(0)
    v_cmp_ne_u32 vcc, 0, v128
    s_cbranch_vccz mega_kernel_fwvd
mega_kernel_restart:
    s_waitcnt vmcnt(0) lgkmcnt(0)
    buffer_wbl2 sc1
    s_waitcnt vmcnt(0)
    s_barrier
    s_mov_b32 s96, 0
    s_mov_b32 s97, 0
    s_lshl_b32 s36, s2, 2
    s_add_u32 s36, s36, 0x1c00
    v_mov_b32 v8, 1
    s_mov_b64 exec, 1
    s_waitcnt vmcnt(0)
    buffer_store_dword v8, off, s[8:11], s36 sc1
    s_mov_b64 exec, -1
    s_movk_i32 s36, 0x1c00
    s_mov_b32 s35, 0
mega_kernel_poll30:
    buffer_load_dwordx4 v[128:131], v1, s[8:11], s36 offen sc1
    s_add_u32 s35, s35, 1
    s_cmp_gt_u32 s35, 20000
    s_cbranch_scc1 mega_kernel_end
    s_waitcnt vmcnt(0)
    v_and_b32 v128, v128, v129
    v_and_b32 v130, v130, v131
    v_and_b32 v128, v128, v130
    v_cmp_ne_u32 vcc, 1, v128
    s_cbranch_vccnz mega_kernel_poll30
mega_kernel_poll30x:
    buffer_inv sc1
    s_movk_i32 s36, 0x1400
    s_waitcnt vmcnt(0)
    buffer_load_dwordx4 v[132:135], v1, s[8:11], s36 offen sc1
    v_lshlrev_b32 v8, 2, v0
    s_or_b32 s39, s98, 0x80
    s_mov_b32 s13, 0
    s_waitcnt vmcnt(0)
    v_add_u32 v9, 0, v8
    v_cmp_gt_u32 s[36:37], s2, v9
    v_cmp_eq_u32 vcc, s39, v132
    s_and_b64 s[36:37], s[36:37], vcc
    s_bcnt1_i32_b64 s36, s[36:37]
    s_add_u32 s13, s13, s36
    v_add_u32 v9, 1, v8
    v_cmp_gt_u32 s[36:37], s2, v9
    v_cmp_eq_u32 vcc, s39, v133
    s_and_b64 s[36:37], s[36:37], vcc
    s_bcnt1_i32_b64 s36, s[36:37]
    s_add_u32 s13, s13, s36
    v_add_u32 v9, 2, v8
    v_cmp_gt_u32 s[36:37], s2, v9
    v_cmp_eq_u32 vcc, s39, v134
    s_and_b64 s[36:37], s[36:37], vcc
    s_bcnt1_i32_b64 s36, s[36:37]
    s_add_u32 s13, s13, s36
    v_add_u32 v9, 3, v8
    v_cmp_gt_u32 s[36:37], s2, v9
    v_cmp_eq_u32 vcc, s39, v135
    s_and_b64 s[36:37], s[36:37], vcc
    s_bcnt1_i32_b64 s36, s[36:37]
    s_add_u32 s13, s13, s36
    s_mov_b32 s12, s98
    s_mov_b32 s39, 0
    s_mov_b32 s38, 0
    v_cmp_eq_u32 vcc, 0x80, v132
    s_bcnt1_i32_b64 s36, vcc
    s_add_u32 s38, s38, s36
    v_cmp_eq_u32 vcc, 0x80, v133
    s_bcnt1_i32_b64 s36, vcc
    s_add_u32 s38, s38, s36
    v_cmp_eq_u32 vcc, 0x80, v134
    s_bcnt1_i32_b64 s36, vcc
    s_add_u32 s38, s38, s36
    v_cmp_eq_u32 vcc, 0x80, v135
    s_bcnt1_i32_b64 s36, vcc
    s_add_u32 s38, s38, s36
    s_xor_b32 s38, s38, 32
    s_or_b32 s39, s39, s38
    s_mov_b32 s38, 0
    v_cmp_eq_u32 vcc, 0x81, v132
    s_bcnt1_i32_b64 s36, vcc
    s_add_u32 s38, s38, s36
    v_cmp_eq_u32 vcc, 0x81, v133
    s_bcnt1_i32_b64 s36, vcc
    s_add_u32 s38, s38, s36
    v_cmp_eq_u32 vcc, 0x81, v134
    s_bcnt1_i32_b64 s36, vcc
    s_add_u32 s38, s38, s36
    v_cmp_eq_u32 vcc, 0x81, v135
    s_bcnt1_i32_b64 s36, vcc
    s_add_u32 s38, s38, s36
    s_xor_b32 s38, s38, 32
    s_or_b32 s39, s39, s38
    s_mov_b32 s38, 0
    v_cmp_eq_u32 vcc, 0x82, v132
    s_bcnt1_i32_b64 s36, vcc
    s_add_u32 s38, s38, s36
    v_cmp_eq_u32 vcc, 0x82, v133
    s_bcnt1_i32_b64 s36, vcc
    s_add_u32 s38, s38, s36
    v_cmp_eq_u32 vcc, 0x82, v134
    s_bcnt1_i32_b64 s36, vcc
    s_add_u32 s38, s38, s36
    v_cmp_eq_u32 vcc, 0x82, v135
    s_bcnt1_i32_b64 s36, vcc
    s_add_u32 s38, s38, s36
    s_xor_b32 s38, s38, 32
    s_or_b32 s39, s39, s38
    s_mov_b32 s38, 0
    v_cmp_eq_u32 vcc, 0x83, v132
    s_bcnt1_i32_b64 s36, vcc
    s_add_u32 s38, s38, s36
    v_cmp_eq_u32 vcc, 0x83, v133
    s_bcnt1_i32_b64 s36, vcc
    s_add_u32 s38, s38, s36
    v_cmp_eq_u32 vcc, 0x83, v134
    s_bcnt1_i32_b64 s36, vcc
    s_add_u32 s38, s38, s36
    v_cmp_eq_u32 vcc, 0x83, v135
    s_bcnt1_i32_b64 s36, vcc
    s_add_u32 s38, s38, s36
    s_xor_b32 s38, s38, 32
    s_or_b32 s39, s39, s38
    s_mov_b32 s38, 0
    v_cmp_eq_u32 vcc, 0x84, v132
    s_bcnt1_i32_b64 s36, vcc
    s_add_u32 s38, s38, s36
    v_cmp_eq_u32 vcc, 0x84, v133
    s_bcnt1_i32_b64 s36, vcc
    s_add_u32 s38, s38, s36
    v_cmp_eq_u32 vcc, 0x84, v134
    s_bcnt1_i32_b64 s36, vcc
    s_add_u32 s38, s38, s36
    v_cmp_eq_u32 vcc, 0x84, v135
    s_bcnt1_i32_b64 s36, vcc
    s_add_u32 s38, s38, s36
    s_xor_b32 s38, s38, 32
    s_or_b32 s39, s39, s38
    s_mov_b32 s38, 0
    v_cmp_eq_u32 vcc, 0x85, v132
    s_bcnt1_i32_b64 s36, vcc
    s_add_u32 s38, s38, s36
    v_cmp_eq_u32 vcc, 0x85, v133
    s_bcnt1_i32_b64 s36, vcc
    s_add_u32 s38, s38, s36
    v_cmp_eq_u32 vcc, 0x85, v134
    s_bcnt1_i32_b64 s36, vcc
    s_add_u32 s38, s38, s36
    v_cmp_eq_u32 vcc, 0x85, v135
    s_bcnt1_i32_b64 s36, vcc
    s_add_u32 s38, s38, s36
    s_xor_b32 s38, s38, 32
    s_or_b32 s39, s39, s38
    s_mov_b32 s38, 0
    v_cmp_eq_u32 vcc, 0x86, v132
    s_bcnt1_i32_b64 s36, vcc
    s_add_u32 s38, s38, s36
    v_cmp_eq_u32 vcc, 0x86, v133
    s_bcnt1_i32_b64 s36, vcc
    s_add_u32 s38, s38, s36
    v_cmp_eq_u32 vcc, 0x86, v134
    s_bcnt1_i32_b64 s36, vcc
    s_add_u32 s38, s38, s36
    v_cmp_eq_u32 vcc, 0x86, v135
    s_bcnt1_i32_b64 s36, vcc
    s_add_u32 s38, s38, s36
    s_xor_b32 s38, s38, 32
    s_or_b32 s39, s39, s38
    s_mov_b32 s38, 0
    v_cmp_eq_u32 vcc, 0x87, v132
    s_bcnt1_i32_b64 s36, vcc
    s_add_u32 s38, s38, s36
    v_cmp_eq_u32 vcc, 0x87, v133
    s_bcnt1_i32_b64 s36, vcc
    s_add_u32 s38, s38, s36
    v_cmp_eq_u32 vcc, 0x87, v134
    s_bcnt1_i32_b64 s36, vcc
    s_add_u32 s38, s38, s36
    v_cmp_eq_u32 vcc, 0x87, v135
    s_bcnt1_i32_b64 s36, vcc
    s_add_u32 s38, s38, s36
    s_xor_b32 s38, s38, 32
    s_or_b32 s39, s39, s38
    s_add_u32 s8, s8, 0x500000
    s_addc_u32 s9, s9, 0
    s_cmp_eq_u32 s39, 0
    s_cbranch_scc1 mega_kernel_role
    s_and_b32 s12, s2, 7
    s_lshr_b32 s13, s2, 3
    s_mov_b32 s15, 1
    s_branch mega_kernel_role
mega_kernel_a_poll:
    s_mov_b32 s35, 0
mega_kernel_poll31:
    buffer_load_dword v126, v124, s[8:11], s43 offen sc1
    s_add_u32 s35, s35, 1
    s_cmp_gt_u32 s35, 20000
    s_cbranch_scc1 mega_kernel_end
    s_and_b32 s34, s35, s96
    s_cmp_eq_u32 s34, 63
    s_cbranch_scc1 mega_kernel_poll31s
    s_waitcnt vmcnt(0)
    v_cmp_ne_u32 vcc, 1, v126
    s_cbranch_vccnz mega_kernel_poll31
mega_kernel_poll31x:
    s_mov_b32 m0, s42
    s_nop 0
    buffer_load_dwordx4 v1, s[8:11], s41 offen sc1 lds
    s_add_u32 m0, m0, 4096
    s_add_u32 s41, s41, 4096
    buffer_load_dwordx4 v1, s[8:11], s41 offen sc1 lds
    s_add_u32 m0, m0, 4096
    s_add_u32 s41, s41, 4096
    buffer_load_dwordx4 v1, s[8:11], s41 offen sc1 lds
    s_add_u32 m0, m0, 4096
    s_add_u32 s41, s41, 4096
    buffer_load_dwordx4 v1, s[8:11], s41 offen sc1 lds
    s_branch mega_kernel_a_polled
mega_kernel_cvd:
    ds_read_b64_tr_b16 v[136:137], v211 offset:0
    ds_read_b64_tr_b16 v[138:139], v211 offset:1024
    ds_read_b64_tr_b16 v[140:141], v211 offset:4096
    ds_read_b64_tr_b16 v[142:143], v211 offset:5120
    ds_read_b64_tr_b16 v[144:145], v211 offset:8192
    ds_read_b64_tr_b16 v[146:147], v211 offset:9216
    ds_read_b64_tr_b16 v[148:149], v211 offset:12288
    ds_read_b64_tr_b16 v[150:151], v211 offset:13312
    s_waitcnt lgkmcnt(6)
    buffer_store_dwordx4 v[136:139], v206, s[4:7], 0 offen sc1
    s_waitcnt lgkmcnt(4)
    buffer_store_dwordx4 v[140:143], v207, s[4:7], 0 offen sc1
    s_waitcnt lgkmcnt(2)
    buffer_store_dwordx4 v[144:147], v208, s[4:7], 0 offen sc1
    s_waitcnt lgkmcnt(0)
    buffer_store_dwordx4 v[148:151], v209, s[4:7], 0 offen sc1
    s_cmp_ge_u32 s2, 112
    s_cbranch_scc1 mega_kernel_cvdd
    v_dot2_f32_bf16 v212, v136, v6, 0
    v_dot2_f32_bf16 v213, v137, v6, 0
    v_dot2_f32_bf16 v212, v138, v6, v212
    v_dot2_f32_bf16 v213, v139, v6, v213
    v_dot2_f32_bf16 v212, v140, v6, v212
    v_dot2_f32_bf16 v213, v141, v6, v213
    v_dot2_f32_bf16 v212, v142, v6, v212
    v_dot2_f32_bf16 v213, v143, v6, v213
    v_dot2_f32_bf16 v212, v144, v6, v212
    v_dot2_f32_bf16 v213, v145, v6, v213
    v_dot2_f32_bf16 v212, v146, v6, v212
    v_dot2_f32_bf16 v213, v147, v6, v213
    v_dot2_f32_bf16 v212, v148, v6, v212
    v_dot2_f32_bf16 v213, v149, v6, v213
    v_dot2_f32_bf16 v212, v150, v6, v212
    v_dot2_f32_bf16 v213, v151, v6, v213
    s_nop 2
    v_add_f32 v212, v212, v213
    v_mov_b32 v213, v212
    s_nop 1
    v_permlane32_swap_b32 v212, v213
    v_add_f32 v212, v212, v213
    v_mov_b32 v213, v212
    s_nop 1
    v_permlane16_swap_b32 v212, v213
    v_add_f32 v212, v212, v213
    v_cvt_pk_bf16_f32 v214, v212, v212
    v_and_b32 v215, 0xffff0000, v214
    v_sub_f32 v215, v212, v215
    v_cvt_pk_bf16_f32 v215, v215, 0
    v_lshl_or_b32 v215, v205, 16, v215
    s_mov_b64 exec, 0xffff
    buffer_store_dwordx2 v[214:215], v210, s[4:7], 0 offen sc1
    s_mov_b64 exec, -1
    s_branch mega_kernel_cvdd
mega_kernel_sig15a:
    buffer_wbl2 sc1
    s_waitcnt vmcnt(0)
    buffer_store_dword v8, off, s[8:11], s39 sc1
    s_branch mega_kernel_sig15b
mega_kernel_a_fb:
    s_lshl_b32 s40, s13, 17
    s_add_u32 s40, s40, 0x10000
    s_mov_b32 s41, 0
    v_mov_b32 v11, 0xff7fffff
mega_kernel_a_fb1:
    s_lshr_b32 s36, s41, 2
    s_lshl_b32 s36, s36, 12
    s_lshl_b32 s37, s41, 10
    s_add_u32 s36, s36, s37
    s_add_u32 s36, s36, s40
    buffer_load_dwordx4 v[20:23], v1, s[8:11], s36 offen sc1
    s_waitcnt vmcnt(0)
    v_mfma_f32_32x32x16_bf16 v[44:59], v[20:23], v[12:15], 0
    s_nop 7
    s_nop 3
    v_max3_f32 v11, v11, v44, v45
    v_max3_f32 v11, v11, v46, v47
    v_max3_f32 v11, v11, v48, v49
    v_max3_f32 v11, v11, v50, v51
    v_max3_f32 v11, v11, v52, v53
    v_max3_f32 v11, v11, v54, v55
    v_max3_f32 v11, v11, v56, v57
    v_max3_f32 v11, v11, v58, v59
    s_add_u32 s41, s41, 1
    s_cmp_lt_u32 s41, 64
    s_cbranch_scc1 mega_kernel_a_fb1
    v_mov_b32 v10, v11
    s_nop 1
    v_permlane32_swap_b32 v10, v11
    v_max_f32 v11, v10, v11
    v_and_b32 v9, 0x1ff, v2
    v_add_u32 v9, 4096, v9
    v_and_b32 v10, 16, v0
    v_cmp_ne_u32 vcc, 0, v10
    s_mov_b32 s41, 0
    v_sub_f32 v60, 0, v11
    v_mov_b32 v92, 0
    v_sub_f32 v61, 0, v11
    v_mov_b32 v93, 0
    v_sub_f32 v62, 0, v11
    v_mov_b32 v94, 0
    v_sub_f32 v63, 0, v11
    v_mov_b32 v95, 0
    v_sub_f32 v64, 0, v11
    v_mov_b32 v96, 0
    v_sub_f32 v65, 0, v11
    v_mov_b32 v97, 0
    v_sub_f32 v66, 0, v11
    v_mov_b32 v98, 0
    v_sub_f32 v67, 0, v11
    v_mov_b32 v99, 0
    v_sub_f32 v68, 0, v11
    v_mov_b32 v100, 0
    v_sub_f32 v69, 0, v11
    v_mov_b32 v101, 0
    v_sub_f32 v70, 0, v11
    v_mov_b32 v102, 0
    v_sub_f32 v71, 0, v11
    v_mov_b32 v103, 0
    v_sub_f32 v72, 0, v11
    v_mov_b32 v104, 0
    v_sub_f32 v73, 0, v11
    v_mov_b32 v105, 0
    v_sub_f32 v74, 0, v11
    v_mov_b32 v106, 0
    v_sub_f32 v75, 0, v11
    v_mov_b32 v107, 0
    v_lshrrev_b32 v11, 1, v1
    v_xor_b32 v11, v11, v1
    v_and_b32 v11, 64, v11
    v_mul_u32_u24 v11, 3, v11
    v_xor_b32 v11, v11, v1
mega_kernel_a_fb2:
    s_lshr_b32 s36, s41, 2
    s_lshl_b32 s36, s36, 12
    s_lshl_b32 s37, s41, 10
    s_add_u32 s36, s36, s37
    s_add_u32 s36, s36, s40
    buffer_load_dwordx4 v[20:23], v11, s[8:11], s36 offen sc1
    buffer_load_dwordx4 v[28:31], v9, s[8:11], s36 offen sc1
    buffer_load_dwordx4 v[32:35], v9, s[8:11], s36 offen offset:512 sc1
    s_waitcnt vmcnt(0)
    v_mfma_f32_32x32x16_bf16 v[44:59], v[20:23], v[12:15], v[60:75]
    v_cndmask_b32 v28, v28, v6
    v_cndmask_b32 v29, v29, v6
    v_cndmask_b32 v30, v30, v6
    v_cndmask_b32 v31, v31, v6
    v_cndmask_b32 v32, v32, v6
    v_cndmask_b32 v33, v33, v6
    v_cndmask_b32 v34, v34, v6
    v_cndmask_b32 v35, v35, v6
    s_nop 3
    v_exp_f32 v44, v44
    v_exp_f32 v45, v45
    v_exp_f32 v46, v46
    v_exp_f32 v47, v47
    v_exp_f32 v48, v48
    v_exp_f32 v49, v49
    v_exp_f32 v50, v50
    v_exp_f32 v51, v51
    v_exp_f32 v52, v52
    v_exp_f32 v53, v53
    v_exp_f32 v54, v54
    v_exp_f32 v55, v55
    v_exp_f32 v56, v56
    v_exp_f32 v57, v57
    v_exp_f32 v58, v58
    v_exp_f32 v59, v59
    v_smfmac_f32_32x32x32_bf16 v[92:107], v[28:31], v[44:51], v127
    s_nop 0
    v_smfmac_f32_32x32x32_bf16 v[92:107], v[32:35], v[52:59], v127
    s_add_u32 s41, s41, 1
    s_cmp_lt_u32 s41, 64
    s_cbranch_scc1 mega_kernel_a_fb2
    s_nop 7
    s_nop 0
    v_rcp_f32 v11, v100
    s_nop 1
    s_branch mega_kernel_a_out
mega_kernel_poll16a:
    buffer_inv sc1
    s_waitcnt vmcnt(0)
    s_branch mega_kernel_poll16b
mega_kernel_sig17a:
    buffer_wbl2 sc1
    s_waitcnt vmcnt(0)
    buffer_store_dword v10, off, s[8:11], s38 sc1
    s_branch mega_kernel_sig17b
mega_kernel_poll18a:
    buffer_inv sc1
    s_waitcnt vmcnt(0)
    s_branch mega_kernel_poll18b
mega_kernel_sig19a:
    buffer_wbl2 sc1
    s_waitcnt vmcnt(0)
    buffer_store_dword v8, off, s[8:11], s43 sc1
    s_branch mega_kernel_sig19b
mega_kernel_poll20a:
    buffer_inv sc1
    s_waitcnt vmcnt(0)
    s_branch mega_kernel_poll20b
mega_kernel_gate21:
    s_mov_b32 s35, 0
mega_kernel_poll32:
    buffer_load_dword v11, v10, s[8:11], s36 offen sc1
    s_add_u32 s35, s35, 1
    s_cmp_gt_u32 s35, 20000
    s_cbranch_scc1 mega_kernel_end
    s_waitcnt vmcnt(0)
    v_cmp_gt_u32 vcc, 2, v11
    s_cbranch_vccnz mega_kernel_poll32
mega_kernel_poll32x:
    s_branch mega_kernel_gate21b
mega_kernel_gate22:
    s_mov_b32 s35, 0
mega_kernel_poll33:
    buffer_load_dword v11, v10, s[8:11], s36 offen sc1
    s_add_u32 s35, s35, 1
    s_cmp_gt_u32 s35, 20000
    s_cbranch_scc1 mega_kernel_end
    s_waitcnt vmcnt(0)
    v_cmp_gt_u32 vcc, 3, v11
    s_cbranch_vccnz mega_kernel_poll33
mega_kernel_poll33x:
    s_branch mega_kernel_gate22b
mega_kernel_gate23:
    s_mov_b32 s35, 0
mega_kernel_poll34:
    buffer_load_dword v11, v10, s[8:11], s36 offen sc1
    s_add_u32 s35, s35, 1
    s_cmp_gt_u32 s35, 20000
    s_cbranch_scc1 mega_kernel_end
    s_waitcnt vmcnt(0)
    v_cmp_gt_u32 vcc, 4, v11
    s_cbranch_vccnz mega_kernel_poll34
mega_kernel_poll34x:
    s_branch mega_kernel_gate23b
mega_kernel_gate24:
    s_mov_b32 s35, 0
mega_kernel_poll35:
    buffer_load_dword v11, v10, s[8:11], s36 offen sc1
    s_add_u32 s35, s35, 1
    s_cmp_gt_u32 s35, 20000
    s_cbranch_scc1 mega_kernel_end
    s_waitcnt vmcnt(0)
    v_cmp_gt_u32 vcc, 5, v11
    s_cbranch_vccnz mega_kernel_poll35
mega_kernel_poll35x:
    s_branch mega_kernel_gate24b
mega_kernel_gate25:
    s_mov_b32 s35, 0
mega_kernel_poll36:
    buffer_load_dword v11, v10, s[8:11], s36 offen sc1
    s_add_u32 s35, s35, 1
    s_cmp_gt_u32 s35, 20000
    s_cbranch_scc1 mega_kernel_end
    s_waitcnt vmcnt(0)
    v_cmp_gt_u32 vcc, 6, v11
    s_cbranch_vccnz mega_kernel_poll36
mega_kernel_poll36x:
    s_branch mega_kernel_gate25b
mega_kernel_gate26:
    s_mov_b32 s35, 0
mega_kernel_poll37:
    buffer_load_dword v11, v10, s[8:11], s36 offen sc1
    s_add_u32 s35, s35, 1
    s_cmp_gt_u32 s35, 20000
    s_cbranch_scc1 mega_kernel_end
    s_waitcnt vmcnt(0)
    v_cmp_gt_u32 vcc, 7, v11
    s_cbranch_vccnz mega_kernel_poll37
mega_kernel_poll37x:
    s_branch mega_kernel_gate26b
mega_kernel_sig27a:
    buffer_wbl2 sc1
    s_waitcnt vmcnt(0)
    buffer_store_dword v10, off, s[8:11], s38 sc1
    s_branch mega_kernel_sig27b
mega_kernel_poll28s:
    s_mov_b64 exec, 1
    v_mov_b32 v132, 1
    s_lshl_b32 s34, s12, 5
    s_add_u32 s34, s34, s13
    s_lshl_b32 s34, s34, 2
    s_add_u32 s34, s34, 0x1800
    s_mov_b64 exec, -1
    v_mov_b32 v132, 1
    v_lshrrev_b32 v133, 3, v0
    v_and_b32 v134, 7, v0
    v_lshlrev_b32 v134, 2, v134
    v_lshl_add_u32 v133, v133, 7, v134
    buffer_atomic_add v132, v133, s[8:11], 0 offen sc1
    s_mov_b64 exec, 1
    s_cmp_lg_u32 s3, 7
    s_cbranch_scc1 mega_kernel_poll28t
    buffer_store_dword v132, off, s[8:11], s34 sc1
    s_or_b32 s34, s98, 0x80
    v_mov_b32 v133, s34
    s_lshl_b32 s34, s2, 2
    s_add_u32 s34, s34, 0x1400
    s_waitcnt vmcnt(0)
    buffer_store_dword v133, off, s[8:11], s34 sc1
mega_kernel_poll28t:
    s_mov_b64 exec, -1
    s_movk_i32 s34, 0x1400
    buffer_load_dwordx4 v[132:135], v1, s[8:11], s34 offen sc1
    s_waitcnt vmcnt(0)
    buffer_load_dwordx4 v[136:139], v1, s[8:11], s34 offen offset:1024 sc1
    v_and_b32 v132, v132, v133
    v_and_b32 v134, v134, v135
    v_and_b32 v132, v132, v134
    v_cmp_gt_u32 vcc, 0x80, v132
    s_waitcnt vmcnt(0)
    s_cbranch_vccnz mega_kernel_poll28
    v_and_b32 v136, v136, v137
    v_and_b32 v138, v138, v139
    v_and_b32 v136, v136, v138
    v_cmp_ne_u32 vcc, 1, v136
    s_cbranch_vccz mega_kernel_poll28
    s_mov_b32 s97, 1
    s_branch mega_kernel_poll28x
mega_kernel_poll31s:
    s_mov_b64 exec, 1
    v_mov_b32 v132, 1
    s_lshl_b32 s34, s12, 5
    s_add_u32 s34, s34, s13
    s_lshl_b32 s34, s34, 2
    s_add_u32 s34, s34, 0x1800
    s_mov_b64 exec, -1
    v_mov_b32 v132, 1
    v_lshrrev_b32 v133, 3, v0
    v_and_b32 v134, 7, v0
    v_lshlrev_b32 v134, 2, v134
    v_lshl_add_u32 v133, v133, 7, v134
    buffer_atomic_add v132, v133, s[8:11], 0 offen sc1
    s_mov_b64 exec, 1
    s_cmp_lg_u32 s3, 7
    s_cbranch_scc1 mega_kernel_poll31t
    buffer_store_dword v132, off, s[8:11], s34 sc1
    s_or_b32 s34, s98, 0x80
    v_mov_b32 v133, s34
    s_lshl_b32 s34, s2, 2
    s_add_u32 s34, s34, 0x1400
    s_waitcnt vmcnt(0)
    buffer_store_dword v133, off, s[8:11], s34 sc1
mega_kernel_poll31t:
    s_mov_b64 exec, -1
    s_movk_i32 s34, 0x1400
    buffer_load_dwordx4 v[132:135], v1, s[8:11], s34 offen sc1
    s_waitcnt vmcnt(0)
    buffer_load_dwordx4 v[136:139], v1, s[8:11], s34 offen offset:1024 sc1
    v_and_b32 v132, v132, v133
    v_and_b32 v134, v134, v135
    v_and_b32 v132, v132, v134
    v_cmp_gt_u32 vcc, 0x80, v132
    s_waitcnt vmcnt(0)
    s_cbranch_vccnz mega_kernel_poll31
    v_and_b32 v136, v136, v137
    v_and_b32 v138, v138, v139
    v_and_b32 v136, v136, v138
    v_cmp_ne_u32 vcc, 1, v136
    s_cbranch_vccz mega_kernel_poll31
    s_mov_b32 s97, 1
    s_branch mega_kernel_poll31x
mega_kernel_cend:
.section .rodata,"a"
.p2align 6
.amdhsa_kernel mega_kernel
  .amdhsa_next_free_vgpr 256
  .amdhsa_next_free_sgpr 102
  .amdhsa_accum_offset 256
  .amdhsa_group_segment_fixed_size 0
  .amdhsa_kernarg_size 88
  .amdhsa_user_sgpr_count 2
  .amdhsa_user_sgpr_kernarg_segment_ptr 1
  .amdhsa_system_sgpr_workgroup_id_x 1
.end_amdhsa_kernel
```
